```python
import torch

def _softmax(x, axis=-1):
    return torch.softmax(x, dim=axis)

def _gelu(x):
    return torch.nn.functional.gelu(x, approximate='tanh')

def _silu(x):
    return torch.nn.functional.silu(x)

def _sigmoid(x):
    return torch.sigmoid(x)

def _layernorm(x, axis=-1, eps=1e-05):
    m = x.mean(dim=axis, keepdim=True)
    v = x.var(dim=axis, keepdim=True, unbiased=False)
    return (x - m) / torch.sqrt(v + eps)

def _scatter_add(tgt, idx, src, axis=0):
    return tgt.clone().index_add_(axis, idx, src)

def _segment_sum(src, seg, n):
    out = torch.zeros((n,) + src.shape[1:], dtype=src.dtype)
    return out.index_add_(0, seg, src)

def _pad(x, pw):
    flat = tuple((v for pair in reversed(pw) for v in pair))
    return torch.nn.functional.pad(x, flat)
kernel_name = 'adaLN_cond__sliding_block_cached__mixer_token_mlp__decode'

def setup_inputs():

    _w = lambda a: (lambda t: t.to(torch.bfloat16) if t.is_floating_point() else t)(torch.as_tensor(a))

    def _A_setup():
        B, Sq, D = (1, 1, 576)
        Hq, Hkv, Sk, Dh = (32, 16, 8192, 128)
        assert Hq % Hkv == 0, (Hq, Hkv)
        return {'x': _w((lambda *s: torch.randn(*s, dtype=torch.bfloat16) * 0.05)(B, Sq, D)), 'k_cache': _w((lambda *s: torch.randn(*s, dtype=torch.bfloat16) * 1.6)(B, Hkv, Sk, Dh)), 'v_cache': _w((lambda *s: torch.randn(*s, dtype=torch.bfloat16) * 1.6)(B, Hkv, Sk, Dh)), 'wq': _w((lambda *s: torch.randn(*s, dtype=torch.bfloat16) * 1.6)(D, Hq * Dh) * D ** (-0.5)), 'wo': _w((lambda *s: torch.randn(*s, dtype=torch.bfloat16) * 1.6)(Hq * Dh, D) * (Hq * Dh) ** (-0.5))}
    _A_in = _A_setup()

    def _B_setup():
        B, S, D, F = (1, 1, 576, 4608)
        return {'x': _w((lambda *s: torch.randn(*s, dtype=torch.bfloat16) * 0.05)(B, S, D)), 'w1': _w((lambda *s: torch.randn(*s, dtype=torch.bfloat16) * 1.6)(S, F) * S ** (-0.5)), 'b1': _w((lambda *s: torch.randn(*s, dtype=torch.bfloat16) * 1.6)(F) * 0.02), 'w2': _w((lambda *s: torch.randn(*s, dtype=torch.bfloat16) * 1.6)(F, S) * F ** (-0.5)), 'b2': _w((lambda *s: torch.randn(*s, dtype=torch.bfloat16) * 1.6)(S) * 0.02)}
    _B_in = _B_setup()
    return {'A_x': _A_in['x'], 'A_k_cache': _A_in['k_cache'], 'A_v_cache': _A_in['v_cache'], 'A_wq': _A_in['wq'], 'A_wo': _A_in['wo'], 'B_x': _B_in['x'], 'B_w1': _B_in['w1'], 'B_b1': _B_in['b1'], 'B_w2': _B_in['w2'], 'B_b2': _B_in['b2'], 'c': _w((lambda *s: torch.randn(*s, dtype=torch.bfloat16) * 0.05)(1, 576) * 8.0), 'w_mod': _w((lambda *s: torch.randn(*s, dtype=torch.bfloat16) * 0.05)(576, 6 * 576) * 576 ** (-0.5) * 8.0)}

def reference(A_x, A_k_cache, A_v_cache, A_wq, A_wo, B_x, B_w1, B_b1, B_w2, B_b2, c, w_mod):

    def _A_ref(x, k_cache, v_cache, wq, wo):
        B, Sq, D = x.shape
        Hq, Dh = (32, 128)
        Hkv, Sk = (k_cache.shape[1], k_cache.shape[2])
        W = min(4096, max(256, Sk // 4))
        rep = Hq // Hkv
        q = (lambda x, *d: x.permute(*d))((x @ wq).reshape(B, Sq, Hq, Dh), 0, 2, 1, 3)
        k = (lambda x, n, axis: torch.repeat_interleave(x, n, dim=axis))(k_cache[:, :, Sk - W:, :], rep, axis=1)
        v = (lambda x, n, axis: torch.repeat_interleave(x, n, dim=axis))(v_cache[:, :, Sk - W:, :], rep, axis=1)
        scores = torch.einsum('bhqd,bhkd->bhqk', q, k) * Dh ** (-0.5)
        p = _softmax(scores, axis=-1)
        o = torch.einsum('bhqk,bhkd->bhqd', p, v)
        return (lambda x, *d: x.permute(*d))(o, 0, 2, 1, 3).reshape(B, Sq, Hq * Dh) @ wo

    def _B_ref(x, w1, b1, w2, b2):
        B, S, D = x.shape
        h = _layernorm(x, axis=-1)
        u = torch.einsum('bsd,sf->bdf', h, w1) + b1
        u = _gelu(u)
        y = torch.einsum('bdf,fs->bds', u, w2) + b2
        return (lambda x, *d: x.permute(*d))(y, 0, 2, 1)
    x = A_x
    mod = (_silu(c) @ w_mod).reshape(c.shape[0], 6, 1, -1)
    sa, ca, ga, sb, cb, gb = (mod[:, 0].clone(), mod[:, 1].clone(), mod[:, 2].clone(), mod[:, 3].clone(), mod[:, 4].clone(), mod[:, 5].clone())
    h = _layernorm(x, axis=-1) * (1 + ca) + sa
    x = x + ga * _A_ref(h, A_k_cache, A_v_cache, A_wq, A_wo)
    h = _layernorm(x, axis=-1) * (1 + cb) + sb
    x = x + gb * _B_ref(h, B_w1, B_b1, B_w2, B_b2)
    return x
```

```asm
; @launch grid=(256,1,1) block=(512,1,1) lds=151552
.amdgcn_target "amdgcn-amd-amdhsa--gfx950"
.text
.globl adaLN_cond__sliding_block_cached__mixer_token_mlp__decode_kernel
.p2align 8
.type adaLN_cond__sliding_block_cached__mixer_token_mlp__decode_kernel,@function
adaLN_cond__sliding_block_cached__mixer_token_mlp__decode_kernel:
    s_cmp_ge_u32 s2, 256
    s_cbranch_scc1 L_END
    s_load_dwordx16 s[8:23], s[0:1], 0
    s_load_dwordx8 s[24:31], s[0:1], 64
    s_load_dwordx4 s[32:35], s[0:1], 96
    s_load_dwordx2 s[36:37], s[0:1], 112
    v_and_b32 v1, 63, v0
    v_lshrrev_b32 v5, 6, v0
    v_lshrrev_b32 v2, 4, v1
    v_readfirstlane_b32 s3, v5
    v_and_b32 v3, 15, v1
    v_min_u32 v11, 287, v0
    v_lshlrev_b32 v17, 4, v11
    v_lshlrev_b32 v11, 2, v11
    v_and_b32 v6, 31, v0
    v_bfe_u32 v7, v0, 5, 1
    v_lshl_add_u32 v6, v6, 1, v7
    v_and_b32 v7, 0x1c0, v0
    v_add_u32 v232, v6, v7
    v_min_u32 v232, 287, v232
    v_lshlrev_b32 v233, 2, v232
    v_lshlrev_b32 v18, 3, v1
    s_mov_b32 s39, 1000000
    s_sub_u32 s6, s2, 64
    s_cmp_ge_u32 s6, 32
    s_cbranch_scc1 L_NCW
    s_cmp_lg_u32 s3, 7
    s_cbranch_scc1 L_NCW
    s_getpc_b64 s[40:41]
L_PCREF:
    v_lshlrev_b32 v8, 7, v1
    global_load_dword v234, v8, s[40:41]
    v_add_u32 v8, 0x2000, v8
    v_min_u32 v8, L_CEND-L_PCREF-4, v8
    global_load_dword v235, v8, s[40:41]
L_NCW:
    s_and_b32 s4, s2, 7
    s_lshr_b32 s5, s2, 3
    s_sub_u32 s6, 31, s5
    s_sub_u32 s7, s5, 16
    s_cmp_lt_u32 s5, 16
    s_cselect_b32 s5, s6, s7
    s_cmp_ge_u32 s5, 16
    s_cbranch_scc1 L_G
    v_xor_b32 v20, v3, v2
    v_lshlrev_b32 v21, 8, v2
    v_lshl_add_u32 v5, v20, 4, v21
    v_xor_b32 v6, 64, v5
    v_xor_b32 v7, 0x80, v5
    v_xor_b32 v8, 0xc0, v5
    v_lshlrev_b32 v22, 1, v2
    v_xor_b32 v22, v3, v22
    v_lshl_add_u32 v9, v22, 4, v21
    v_xor_b32 v10, 0x80, v9
    s_lshr_b32 s6, s5, 3
    s_lshl_b32 s7, s4, 1
    s_add_u32 s6, s6, s7
    s_and_b32 s7, s5, 7
    s_lshl_b32 s56, s6, 21
    s_lshl_b32 s57, s7, 16
    s_add_u32 s56, s56, s57
    s_lshl_b32 s58, s3, 13
    s_add_u32 s56, s56, s58
    s_add_u32 s56, s56, 1572864
    s_add_u32 s57, s56, 4096
    s_mov_b32 m0, s58
    s_waitcnt lgkmcnt(0)
    global_load_dword v12, v233, s[8:9]
    s_load_dword s38, s[36:37], 0
    s_mov_b32 s40, s10
    s_and_b32 s41, s11, 0xffff
    s_mov_b32 s42, 33554432
    s_mov_b32 s43, 0x20000
    s_mov_b32 s44, s12
    s_and_b32 s45, s13, 0xffff
    s_mov_b32 s46, 33554432
    s_mov_b32 s47, 0x20000
    s_mov_b32 s52, s36
    s_and_b32 s53, s37, 0xffff
    s_mov_b32 s54, 2097152
    s_mov_b32 s55, 0x20000
    buffer_load_dwordx4 v5, s[40:43], s56 offen offset:0 nt lds
    buffer_load_dwordx4 v6, s[40:43], s56 offen offset:1024 nt lds
    buffer_load_dwordx4 v7, s[40:43], s56 offen offset:2048 nt lds
    buffer_load_dwordx4 v8, s[40:43], s56 offen offset:3072 nt lds
    s_add_u32 m0, m0, 4096
    s_nop 0
    buffer_load_dwordx4 v5, s[40:43], s57 offen offset:0 nt lds
    buffer_load_dwordx4 v6, s[40:43], s57 offen offset:1024 nt lds
    buffer_load_dwordx4 v7, s[40:43], s57 offen offset:2048 nt lds
    buffer_load_dwordx4 v8, s[40:43], s57 offen offset:3072 nt lds
    s_add_u32 m0, s58, 65536
    s_nop 0
    buffer_load_dwordx4 v9, s[44:47], s56 offen offset:0 nt lds
    buffer_load_dwordx4 v10, s[44:47], s56 offen offset:1024 nt lds
    buffer_load_dwordx4 v9, s[44:47], s56 offen offset:2048 nt lds
    buffer_load_dwordx4 v10, s[44:47], s56 offen offset:3072 nt lds
    s_add_u32 m0, m0, 4096
    s_nop 0
    buffer_load_dwordx4 v9, s[44:47], s57 offen offset:0 nt lds
    buffer_load_dwordx4 v10, s[44:47], s57 offen offset:1024 nt lds
    buffer_load_dwordx4 v9, s[44:47], s57 offen offset:2048 nt lds
    buffer_load_dwordx4 v10, s[44:47], s57 offen offset:3072 nt lds
    v_lshlrev_b32 v26, 8, v3
    v_lshl_add_u32 v26, v20, 4, v26
    v_add_u32 v26, s58, v26
    v_xor_b32 v27, 64, v26
    v_xor_b32 v28, 0x80, v26
    v_xor_b32 v29, 0xc0, v26
    v_lshrrev_b32 v21, 2, v1
    v_and_b32 v22, 7, v21
    v_lshlrev_b32 v22, 5, v22
    v_lshl_add_u32 v22, v21, 8, v22
    v_and_b32 v21, 3, v1
    v_lshl_add_u32 v22, v21, 3, v22
    s_add_u32 s59, s58, 65536
    v_add_u32 v224, s59, v22
    v_xor_b32 v225, 32, v224
    v_xor_b32 v226, 64, v224
    v_xor_b32 v227, 96, v224
    v_xor_b32 v228, 128, v224
    v_xor_b32 v229, 160, v224
    v_xor_b32 v230, 192, v224
    v_xor_b32 v231, 224, v224
    v_and_b32 v23, 1, v3
    v_lshlrev_b32 v23, 8, v23
    v_lshl_add_u32 v23, v2, 4, v23
    v_add_u32 v23, 135168, v23
    v_lshlrev_b32 v24, 4, v1
    s_lshl_b32 s59, s3, 8
    s_add_u32 s59, s59, 135168
    v_lshl_add_u32 v25, v1, 2, s59
    v_mov_b32 v164, 0x3f803f80
    v_mov_b32 v165, 0x3f803f80
    v_mov_b32 v166, 0x3f803f80
    v_mov_b32 v167, 0x3f803f80
    s_lshl_b32 s60, s6, 11
    s_lshl_b32 s61, s3, 10
    s_add_u32 s60, s60, s61
    s_add_u32 s60, s60, 32768
    s_add_u32 s61, s60, 32768
    s_mov_b32 s62, 0x3db504f3
    s_mov_b32 s63, 0x3fb8aa3b
    s_lshl_b32 s59, s3, 10
    s_add_u32 s59, s59, 136192
    v_lshl_add_u32 v13, v1, 2, s59
    s_lshl_b32 s59, s3, 2
    s_add_u32 s59, s59, 135680
    v_lshl_add_u32 v14, v1, 6, s59
    s_and_b32 s59, s3, 1
    s_lshl_b32 s64, s59, 9
    s_add_u32 s64, s64, 136192
    v_lshl_add_u32 v15, v1, 3, s64
    s_lshl_b32 s64, s59, 6
    s_add_u32 s64, s64, 135680
    v_mov_b32 v16, s64
    s_lshl_b32 s64, s6, 1
    s_add_u32 s64, s64, s59
    s_lshl_b32 s65, s64, 12
    s_lshl_b32 s66, s7, 9
    s_add_u32 s65, s65, s66
    s_add_u32 s65, s65, 98304
    s_lshl_b32 s66, s64, 7
    s_lshl_b32 s67, s7, 4
    s_add_u32 s66, s66, s67
    s_add_u32 s66, s66, 360448
    s_lshl_b32 s68, s4, 4
    s_add_u32 s68, s68, s5
    s_lshl_b32 s67, s68, 3
    s_add_u32 s67, s67, 475136
    v_cmp_eq_u32 vcc, 1, v1
    s_nop 0
    s_mov_b64 s[48:49], vcc
    s_add_u32 s50, s60, 524288
    s_add_u32 s51, s61, 524288
    s_getreg_b32 s69, hwreg(HW_REG_XCC_ID)
    s_and_b32 s69, s69, 15
    v_mov_b32 v30, s69
    s_waitcnt lgkmcnt(0)
    s_mul_i32 s38, s38, 1664525
    s_add_u32 s38, s38, 1013904223
    v_mov_b32 v4, s38
    v_mov_b32 v31, s38
    s_cmp_ge_u32 s3, 2
    s_cbranch_scc1 A_NQ1
    buffer_load_dwordx4 v[120:123], v24, s[52:55], s50 offen sc1
    buffer_load_dwordx4 v[124:127], v24, s[52:55], s51 offen sc1
    s_branch A_ISSUED_P
A_NQ1:
    s_cmp_lg_u32 s3, 2
    s_cbranch_scc1 A_NT
    s_mov_b64 exec, 1
    buffer_store_dwordx2 v[30:31], v18, s[52:55], s67 offen sc0 sc1
    s_mov_b64 exec, -1
A_NT:
    s_waitcnt vmcnt(8)
    ds_read_b128 v[32:35], v26 offset:0
    ds_read_b128 v[36:39], v27 offset:0
    ds_read_b128 v[40:43], v28 offset:0
    ds_read_b128 v[44:47], v29 offset:0
    ds_read_b128 v[48:51], v26 offset:4096
    ds_read_b128 v[52:55], v27 offset:4096
    ds_read_b128 v[56:59], v28 offset:4096
    ds_read_b128 v[60:63], v29 offset:4096
    s_branch A_B1
A_ISSUED_P:
    s_waitcnt vmcnt(8)
    ds_read_b128 v[32:35], v26 offset:0
    ds_read_b128 v[36:39], v27 offset:0
    ds_read_b128 v[40:43], v28 offset:0
    ds_read_b128 v[44:47], v29 offset:0
    ds_read_b128 v[48:51], v26 offset:4096
    ds_read_b128 v[52:55], v27 offset:4096
    ds_read_b128 v[56:59], v28 offset:4096
    ds_read_b128 v[60:63], v29 offset:4096
    s_waitcnt vmcnt(0)
A_QCHK:
    v_xor_b32 v130, v121, v4
    v_bitop3_b32 v130, v130, v123, v4 bitop3:0xf6
    v_bitop3_b32 v130, v130, v125, v4 bitop3:0xf6
    v_bitop3_b32 v130, v130, v127, v4 bitop3:0xf6
    v_cmp_ne_u32 vcc, 0, v130
    s_cbranch_vccnz A_QRETRY
    v_add_f32 v120, v120, v124
    v_add_f32 v122, v122, v126
    v_cvt_pk_bf16_f32 v120, v120, v122
    ds_write_b32 v25, v120
A_B1:
    s_mov_b32 s40, 0xcccccccc
    s_mov_b32 s41, s40
    s_mov_b32 s42, 0xf0f0f0f0
    s_mov_b32 s43, s42
    s_mov_b32 s44, 0xff00ff00
    s_mov_b32 s45, s44
    s_waitcnt lgkmcnt(0)
    s_cmp_ge_u32 s3, 4
    s_cbranch_scc1 A_PR
    s_setprio 2
A_PR:
    s_barrier
    ds_read_b128 v[96:99], v23 offset:0
    ds_read_b128 v[100:103], v23 offset:64
    ds_read_b128 v[104:107], v23 offset:128
    ds_read_b128 v[108:111], v23 offset:192
    s_waitcnt lgkmcnt(3)
    v_mfma_f32_16x16x32_bf16 v[112:115], v[32:35], v[96:99], 0
    v_mfma_f32_16x16x32_bf16 v[116:119], v[48:51], v[96:99], 0
    s_waitcnt lgkmcnt(2)
    v_mfma_f32_16x16x32_bf16 v[112:115], v[36:39], v[100:103], v[112:115]
    v_mfma_f32_16x16x32_bf16 v[116:119], v[52:55], v[100:103], v[116:119]
    s_waitcnt lgkmcnt(1)
    v_mfma_f32_16x16x32_bf16 v[112:115], v[40:43], v[104:107], v[112:115]
    v_mfma_f32_16x16x32_bf16 v[116:119], v[56:59], v[104:107], v[116:119]
    s_waitcnt lgkmcnt(0)
    v_mfma_f32_16x16x32_bf16 v[112:115], v[44:47], v[108:111], v[112:115]
    v_mfma_f32_16x16x32_bf16 v[116:119], v[60:63], v[108:111], v[116:119]
    s_cmp_eq_u32 s3, 2
    s_cbranch_scc1 A_VW
    s_waitcnt vmcnt(0)
A_VW:
    s_waitcnt vmcnt(1)
    ds_read_b64_tr_b16 v[64:65], v224 offset:0
    ds_read_b64_tr_b16 v[66:67], v224 offset:4096
    ds_read_b64_tr_b16 v[68:69], v225 offset:0
    ds_read_b64_tr_b16 v[70:71], v225 offset:4096
    ds_read_b64_tr_b16 v[72:73], v226 offset:0
    ds_read_b64_tr_b16 v[74:75], v226 offset:4096
    ds_read_b64_tr_b16 v[76:77], v227 offset:0
    ds_read_b64_tr_b16 v[78:79], v227 offset:4096
    ds_read_b64_tr_b16 v[80:81], v228 offset:0
    ds_read_b64_tr_b16 v[82:83], v228 offset:4096
    ds_read_b64_tr_b16 v[84:85], v229 offset:0
    ds_read_b64_tr_b16 v[86:87], v229 offset:4096
    v_cndmask_b32 v112, v112, v113, s[40:41]
    v_cndmask_b32 v114, v114, v115, s[40:41]
    v_cndmask_b32 v116, v116, v117, s[40:41]
    v_cndmask_b32 v118, v118, v119, s[40:41]
    v_cndmask_b32 v112, v112, v114, s[42:43]
    v_cndmask_b32 v116, v116, v118, s[42:43]
    v_cndmask_b32 v112, v112, v116, s[44:45]
    v_cvt_pk_bf16_f32 v112, v112, v112
    v_and_b32 v112, 0xffff0000, v112
    v_mul_f32 v112, s62, v112
    v_cvt_pk_bf16_f32 v112, v112, v112
    v_and_b32 v112, 0xffff0000, v112
    s_waitcnt lgkmcnt(8)
    ds_read_b64_tr_b16 v[88:89], v230 offset:0
    ds_read_b64_tr_b16 v[90:91], v230 offset:4096
    v_max_f32_dpp v124, v112, v112 row_ror:2 row_mask:0xf bank_mask:0xf
    ds_read_b64_tr_b16 v[92:93], v231 offset:0
    ds_read_b64_tr_b16 v[94:95], v231 offset:4096
    v_max_f32_dpp v124, v124, v124 row_ror:4 row_mask:0xf bank_mask:0xf
    v_mul_f32 v112, s63, v112
    s_nop 0
    v_max_f32_dpp v124, v124, v124 row_ror:8 row_mask:0xf bank_mask:0xf
    v_mov_b32 v125, v124
    s_nop 1
    v_permlane16_swap_b32 v124, v125
    v_max_f32 v124, v124, v125
    v_mov_b32 v125, v124
    s_nop 1
    v_permlane32_swap_b32 v124, v125
    v_max_f32 v124, v124, v125
    v_mul_f32 v124, s63, v124
    v_sub_f32 v112, v112, v124
    v_exp_f32 v112, v112
    s_nop 1
    v_mov_b32_dpp v113, v112 row_shl:2 row_mask:0xf bank_mask:0xf bound_ctrl:0
    v_cvt_pk_bf16_f32 v168, v112, v113
    s_nop 1
    v_mov_b32_dpp v169, v168 row_shl:4 row_mask:0xf bank_mask:0xf bound_ctrl:0
    v_mov_b32_dpp v170, v168 row_shl:8 row_mask:0xf bank_mask:0xf bound_ctrl:0
    v_mov_b32_dpp v171, v168 row_shl:12 row_mask:0xf bank_mask:0xf bound_ctrl:0
    s_waitcnt lgkmcnt(0)
    s_nop 0
    v_mfma_f32_16x16x32_bf16 v[128:131], v[168:171], v[64:67], 0
    v_mfma_f32_16x16x32_bf16 v[160:163], v[168:171], v[164:167], 0
    v_mfma_f32_16x16x32_bf16 v[132:135], v[168:171], v[68:71], 0
    v_mfma_f32_16x16x32_bf16 v[136:139], v[168:171], v[72:75], 0
    v_mfma_f32_16x16x32_bf16 v[140:143], v[168:171], v[76:79], 0
    v_mfma_f32_16x16x32_bf16 v[144:147], v[168:171], v[80:83], 0
    v_mfma_f32_16x16x32_bf16 v[148:151], v[168:171], v[84:87], 0
    v_mfma_f32_16x16x32_bf16 v[152:155], v[168:171], v[88:91], 0
    v_mfma_f32_16x16x32_bf16 v[156:159], v[168:171], v[92:95], 0
    s_mov_b64 exec, 3
    ds_write_b32 v14, v124
    v_cndmask_b32 v160, v160, v161, s[48:49]
    ds_write_b32 v14, v160 offset:32
    s_mov_b64 exec, 0xffff
    ds_write2_b32 v13, v128, v129 offset0:0 offset1:128
    ds_write2_b32 v13, v132, v133 offset0:16 offset1:144
    ds_write2_b32 v13, v136, v137 offset0:32 offset1:160
    ds_write2_b32 v13, v140, v141 offset0:48 offset1:176
    ds_write2_b32 v13, v144, v145 offset0:64 offset1:192
    ds_write2_b32 v13, v148, v149 offset0:80 offset1:208
    ds_write2_b32 v13, v152, v153 offset0:96 offset1:224
    ds_write2_b32 v13, v156, v157 offset0:112 offset1:240
    s_mov_b64 exec, -1
    s_waitcnt lgkmcnt(0)
    s_barrier
    s_cmp_ge_u32 s3, 2
    s_cbranch_scc1 A_DONE
    ds_read_b128 v[32:35], v16
    ds_read_b128 v[36:39], v16 offset:16
    ds_read2st64_b64 v[64:67], v15 offset0:0 offset1:2
    ds_read2st64_b64 v[68:71], v15 offset0:4 offset1:6
    ds_read2st64_b64 v[72:75], v15 offset0:8 offset1:10
    ds_read2st64_b64 v[76:79], v15 offset0:12 offset1:14
    ds_read_b128 v[40:43], v16 offset:32
    ds_read_b128 v[44:47], v16 offset:48
    v_mov_b32 v61, v4
    v_mov_b32 v57, v4
    v_mov_b32 v59, v4
    s_waitcnt lgkmcnt(6)
    v_max3_f32 v56, v32, v33, v34
    v_max3_f32 v58, v35, v36, v37
    v_max3_f32 v56, v56, v38, v39
    v_max_f32 v56, v56, v58
    v_pk_add_f32 v[32:33], v[32:33], v[56:57] op_sel_hi:[1,0] neg_lo:[0,1] neg_hi:[0,1]
    v_pk_add_f32 v[34:35], v[34:35], v[56:57] op_sel_hi:[1,0] neg_lo:[0,1] neg_hi:[0,1]
    v_pk_add_f32 v[36:37], v[36:37], v[56:57] op_sel_hi:[1,0] neg_lo:[0,1] neg_hi:[0,1]
    v_pk_add_f32 v[38:39], v[38:39], v[56:57] op_sel_hi:[1,0] neg_lo:[0,1] neg_hi:[0,1]
    v_exp_f32 v32, v32
    v_exp_f32 v33, v33
    v_exp_f32 v34, v34
    v_exp_f32 v35, v35
    v_exp_f32 v36, v36
    v_exp_f32 v37, v37
    v_exp_f32 v38, v38
    v_exp_f32 v39, v39
    s_waitcnt lgkmcnt(2)
    v_pk_mul_f32 v[62:63], v[32:33], v[64:65] op_sel:[0,0] op_sel_hi:[0,1]
    v_pk_mul_f32 v[48:49], v[32:33], v[66:67] op_sel:[1,0] op_sel_hi:[1,1]
    v_pk_fma_f32 v[62:63], v[34:35], v[68:69], v[62:63] op_sel:[0,0,0] op_sel_hi:[0,1,1]
    v_pk_fma_f32 v[48:49], v[34:35], v[70:71], v[48:49] op_sel:[1,0,0] op_sel_hi:[1,1,1]
    v_pk_fma_f32 v[62:63], v[36:37], v[72:73], v[62:63] op_sel:[0,0,0] op_sel_hi:[0,1,1]
    v_pk_fma_f32 v[48:49], v[36:37], v[74:75], v[48:49] op_sel:[1,0,0] op_sel_hi:[1,1,1]
    v_pk_fma_f32 v[62:63], v[38:39], v[76:77], v[62:63] op_sel:[0,0,0] op_sel_hi:[0,1,1]
    v_pk_fma_f32 v[48:49], v[38:39], v[78:79], v[48:49] op_sel:[1,0,0] op_sel_hi:[1,1,1]
    v_pk_add_f32 v[62:63], v[62:63], v[48:49]
    s_waitcnt lgkmcnt(0)
    v_pk_mul_f32 v[50:51], v[32:33], v[40:41]
    v_cvt_pk_bf16_f32 v60, v62, v63
    s_add_u32 s1, s65, 524288
    buffer_store_dwordx2 v[60:61], v18, s[52:55], s1 offen
    buffer_store_dwordx2 v[60:61], v18, s[52:55], s65 offen sc0 sc1
    v_pk_fma_f32 v[50:51], v[34:35], v[42:43], v[50:51]
    v_pk_fma_f32 v[50:51], v[36:37], v[44:45], v[50:51]
    v_pk_fma_f32 v[50:51], v[38:39], v[46:47], v[50:51]
    v_add_f32 v58, v50, v51
    s_mov_b64 exec, 1
    s_add_u32 s1, s66, 524288
    buffer_store_dwordx4 v[56:59], v18, s[52:55], s1 offen
    buffer_store_dwordx4 v[56:59], v18, s[52:55], s66 offen sc0 sc1
    s_mov_b64 exec, -1
A_DONE:
    s_setprio 0
    s_barrier
    v_lshlrev_b32 v221, 4, v0
    v_lshlrev_b32 v222, 1, v0
    v_add_u32 v222, 0x2000, v222
    v_mov_b32 v223, 0
    global_load_dwordx4 v[206:209], v221, s[20:21]
    global_load_dwordx4 v[210:213], v221, s[22:23]
    global_load_dwordx4 v[214:217], v221, s[24:25]
    global_load_ushort v218, v222, s[20:21]
    global_load_ushort v219, v222, s[22:23]
    global_load_ushort v220, v222, s[24:25]
    global_load_ushort v223, v223, s[26:27]
    s_branch L_F
A_QRETRY:
    s_sub_u32 s39, s39, 1
    s_cbranch_scc1 L_FAIL
    s_and_b32 s1, s39, 7
    s_cbranch_scc0 A_QRG
    buffer_load_dwordx4 v[120:123], v24, s[52:55], s50 offen sc1
    buffer_load_dwordx4 v[124:127], v24, s[52:55], s51 offen sc1
    s_waitcnt vmcnt(0)
    s_branch A_QCHK
A_QRG:
    buffer_load_dwordx4 v[120:123], v24, s[52:55], s60 offen sc1
    buffer_load_dwordx4 v[124:127], v24, s[52:55], s61 offen sc1
    s_waitcnt vmcnt(0)
    s_branch A_QCHK
L_G:
    s_sub_u32 s5, s5, 16
    v_lshrrev_b32 v20, 3, v1
    v_and_b32 v21, 7, v1
    v_lshlrev_b32 v22, 1, v2
    v_xor_b32 v21, v21, v22
    v_lshlrev_b32 v21, 4, v21
    v_mul_u32_u24 v5, 6912, v20
    v_add_u32 v5, v5, v21
    v_lshl_add_u32 v6, v20, 13, v21
    v_mul_u32_u24 v7, 1152, v20
    v_add_u32 v7, v7, v21
    s_max_u32 s6, s3, 4
    s_sub_u32 s6, s6, 4
    s_lshl_b32 s6, s6, 6
    v_add_u32 v15, s6, v1
    v_min_u32 v15, 191, v15
    s_lshr_b32 s7, s5, 3
    s_mul_i32 s56, s7, 96
    v_max_u32 v15, s56, v15
    s_lshl_b32 s56, s56, 2
    v_lshl_add_u32 v16, v15, 2, s56
    s_sub_u32 s57, s5, 9
    s_lshl_b32 s57, s57, 3
    s_add_u32 s57, s57, s4
    s_cmp_ge_u32 s57, 18
    s_cselect_b32 s58, 1, 0
    s_cmp_ge_u32 s57, 36
    s_cselect_b32 s58, 2, s58
    s_mul_i32 s59, s58, 18
    s_sub_u32 s59, s57, s59
    s_mul_i32 s60, s58, 1327104
    s_lshl_b32 s61, s59, 7
    s_add_u32 s60, s60, s61
    s_mul_i32 s61, s3, 55296
    s_add_u32 s60, s60, s61
    s_lshl_b32 s62, s3, 10
    s_and_b32 s63, s5, 7
    s_lshl_b32 s64, s4, 3
    s_add_u32 s63, s63, s64
    s_mul_i32 s64, s7, 3145728
    s_lshl_b32 s65, s63, 7
    s_add_u32 s64, s64, s65
    s_lshl_b32 s65, s3, 16
    s_add_u32 s64, s64, s65
    s_mov_b32 m0, s62
    s_waitcnt lgkmcnt(0)
    global_load_dword v13, v11, s[28:29]
    global_load_dword v12, v11, s[8:9]
    global_load_dword v14, v16, s[8:9]
    s_mov_b32 s40, s30
    s_and_b32 s41, s31, 0xffff
    s_mov_b32 s42, 3981312
    s_mov_b32 s43, 0x20000
    s_cmp_ge_u32 s57, 54
    s_cbranch_scc1 G_NOH
    buffer_load_dwordx4 v5, s[40:43], s60 offen nt lds
    s_add_u32 m0, m0, 8192
    s_add_u32 s60, s60, 442368
    buffer_load_dwordx4 v5, s[40:43], s60 offen nt lds
    s_add_u32 m0, m0, 8192
    s_add_u32 s60, s60, 442368
    buffer_load_dwordx4 v5, s[40:43], s60 offen nt lds
G_NOH:
    s_mov_b32 s44, s14
    s_and_b32 s45, s15, 0xffff
    s_mov_b32 s46, 4718592
    s_mov_b32 s47, 0x20000
    s_mov_b32 s48, s16
    s_and_b32 s49, s17, 0xffff
    s_mov_b32 s50, 4718592
    s_mov_b32 s51, 0x20000
    s_load_dword s38, s[36:37], 0
    s_mov_b32 s52, s36
    s_and_b32 s53, s37, 0xffff
    s_mov_b32 s54, 2097152
    s_mov_b32 s55, 0x20000
    v_lshrrev_b32 v20, 2, v1
    v_bfe_u32 v21, v1, 3, 2
    s_and_b32 s6, s3, 3
    v_xor_b32 v21, s6, v21
    v_lshlrev_b32 v21, 5, v21
    v_lshl_add_u32 v8, v20, 7, v21
    v_and_b32 v21, 3, v1
    v_lshl_add_u32 v8, v21, 3, v8
    v_add_u32 v9, 61440, v8
    v_lshlrev_b32 v10, 4, v2
    v_add_u32 v10, 135168, v10
    s_mul_i32 s60, s58, 384
    v_add_u32 v19, s60, v10
    v_lshlrev_b32 v30, 2, v16
    v_add_u32 v31, 4608, v30
    v_lshrrev_b32 v23, 4, v0
    v_lshlrev_b32 v23, 6, v23
    v_bfe_u32 v20, v0, 1, 2
    v_lshl_add_u32 v23, v20, 4, v23
    v_bfe_u32 v20, v0, 3, 1
    v_lshl_add_u32 v23, v20, 3, v23
    v_and_b32 v20, 1, v0
    v_lshl_add_u32 v23, v20, 2, v23
    v_add_u32 v23, 135168, v23
    v_lshrrev_b32 v24, 4, v15
    v_lshlrev_b32 v24, 6, v24
    v_bfe_u32 v20, v15, 1, 2
    v_lshl_add_u32 v24, v20, 4, v24
    v_bfe_u32 v20, v15, 3, 1
    v_lshl_add_u32 v24, v20, 3, v24
    v_and_b32 v20, 1, v15
    v_lshl_add_u32 v24, v20, 2, v24
    v_add_u32 v24, 136320, v24
    s_lshl_b32 s60, s3, 3
    s_add_u32 s60, s60, 138496
    v_mov_b32 v25, s60
    v_mov_b32 v26, 138496
    v_cmp_gt_u32 vcc, 0x120, v0
    s_nop 0
    s_mov_b64 s[66:67], vcc
    s_mul_i32 s60, s58, 9216
    s_lshl_b32 s61, s59, 9
    s_add_u32 s60, s60, s61
    s_lshl_b32 s61, s6, 7
    s_add_u32 s60, s60, s61
    s_add_u32 s60, s60, 4096
    s_lshl_b32 s65, s7, 15
    s_lshl_b32 s69, s63, 9
    s_add_u32 s65, s65, s69
    s_add_u32 s65, s65, s61
    s_add_u32 s65, s65, 32768
    s_mov_b32 s61, 0xbfb8aa3b
    s_waitcnt lgkmcnt(0)
    s_mul_i32 s38, s38, 1664525
    s_add_u32 s38, s38, 1013904223
    v_mov_b32 v4, s38
    s_cmp_lt_u32 s57, 54
    s_cbranch_scc1 G_W3
    s_waitcnt vmcnt(0)
    s_mul_i32 s0, s7, 24576
    s_add_u32 m0, s62, s0
    s_cmp_lg_u32 s7, 0
    s_cbranch_scc1 G_Q3
    buffer_load_dwordx4 v6, s[44:47], s64 offen nt lds
    s_add_u32 m0, m0, 8192
    s_add_u32 s64, s64, 524288
    buffer_load_dwordx4 v6, s[44:47], s64 offen nt lds
    s_add_u32 m0, m0, 8192
    s_add_u32 s64, s64, 524288
    buffer_load_dwordx4 v6, s[44:47], s64 offen nt lds
    s_add_u32 m0, m0, 8192
    s_add_u32 s64, s64, 524288
G_Q3:
    buffer_load_dwordx4 v6, s[44:47], s64 offen nt lds
    s_add_u32 m0, m0, 8192
    s_add_u32 s64, s64, 524288
    buffer_load_dwordx4 v6, s[44:47], s64 offen nt lds
    s_add_u32 m0, m0, 8192
    s_add_u32 s64, s64, 524288
    buffer_load_dwordx4 v6, s[44:47], s64 offen nt lds
    s_mul_i32 s64, s4, 589824
    s_lshl_b32 s0, s5, 7
    s_add_u32 s64, s64, s0
    s_mul_i32 s0, s3, 9216
    s_add_u32 s64, s64, s0
    s_branch G_W3B
G_W3:
    s_waitcnt vmcnt(3)
G_W3B:
    v_lshlrev_b32 v27, 16, v13
    v_and_b32 v28, 0xffff0000, v13
    v_mul_f32 v29, s61, v27
    v_mul_f32 v36, s61, v28
    v_exp_f32 v29, v29
    v_exp_f32 v36, v36
    v_lshlrev_b32 v32, 16, v12
    v_and_b32 v33, 0xffff0000, v12
    v_add_f32 v29, 1.0, v29
    v_add_f32 v36, 1.0, v36
    v_rcp_f32 v29, v29
    v_rcp_f32 v36, v36
    v_add_f32 v34, v32, v33
    v_mul_f32 v35, v32, v32
    v_fmac_f32 v35, v33, v33
    v_mul_f32 v27, v27, v29
    v_mul_f32 v28, v28, v36
    v_cvt_pk_bf16_f32 v27, v27, v28
    v_cndmask_b32 v34, 0, v34, s[66:67]
    v_cndmask_b32 v35, 0, v35, s[66:67]
    s_mov_b64 exec, s[66:67]
    ds_write_b32 v23, v27
    s_mov_b64 exec, -1
    v_add_f32_dpp v34, v34, v34 row_shr:1 row_mask:0xf bank_mask:0xf
    v_add_f32_dpp v35, v35, v35 row_shr:1 row_mask:0xf bank_mask:0xf
    s_nop 0
    v_add_f32_dpp v34, v34, v34 row_shr:2 row_mask:0xf bank_mask:0xf
    v_add_f32_dpp v35, v35, v35 row_shr:2 row_mask:0xf bank_mask:0xf
    s_nop 0
    v_add_f32_dpp v34, v34, v34 row_shr:4 row_mask:0xf bank_mask:0xf
    v_add_f32_dpp v35, v35, v35 row_shr:4 row_mask:0xf bank_mask:0xf
    s_nop 0
    v_add_f32_dpp v34, v34, v34 row_shr:8 row_mask:0xf bank_mask:0xf
    v_add_f32_dpp v35, v35, v35 row_shr:8 row_mask:0xf bank_mask:0xf
    s_nop 0
    v_add_f32_dpp v34, v34, v34 row_bcast:15 row_mask:0xa bank_mask:0xf
    v_add_f32_dpp v35, v35, v35 row_bcast:15 row_mask:0xa bank_mask:0xf
    s_nop 0
    v_add_f32_dpp v34, v34, v34 row_bcast:31 row_mask:0xc bank_mask:0xf
    v_add_f32_dpp v35, v35, v35 row_bcast:31 row_mask:0xc bank_mask:0xf
    s_mov_b32 exec_lo, 0
    s_brev_b32 exec_hi, 1
    ds_write_b64 v25, v[34:35]
    s_mov_b64 exec, -1
    s_cmp_ge_u32 s57, 54
    s_cbranch_scc1 G_W6
    s_waitcnt vmcnt(0)
G_W6:
    s_waitcnt lgkmcnt(0)
    s_barrier
    s_cmp_ge_u32 s57, 54
    s_cbranch_scc1 G_H9
    s_cmp_ge_u32 s3, 4
    s_cbranch_scc1 G_H8
    ds_read_b64_tr_b16 v[32:33], v8 offset:0
    ds_read_b64_tr_b16 v[34:35], v8 offset:2048
    ds_read_b128 v[104:107], v19 offset:0
    ds_read_b64_tr_b16 v[36:37], v8 offset:4096
    ds_read_b64_tr_b16 v[38:39], v8 offset:6144
    ds_read_b128 v[108:111], v19 offset:64
    ds_read_b64_tr_b16 v[40:41], v8 offset:8192
    ds_read_b64_tr_b16 v[42:43], v8 offset:10240
    ds_read_b128 v[112:115], v19 offset:128
    ds_read_b64_tr_b16 v[44:45], v8 offset:12288
    ds_read_b64_tr_b16 v[46:47], v8 offset:14336
    ds_read_b128 v[116:119], v19 offset:192
    s_waitcnt lgkmcnt(9)
    v_mfma_f32_16x16x32_bf16 v[172:175], v[104:107], v[32:35], 0
    ds_read_b64_tr_b16 v[48:49], v8 offset:16384
    ds_read_b64_tr_b16 v[50:51], v8 offset:18432
    ds_read_b128 v[120:123], v19 offset:256
    s_waitcnt lgkmcnt(9)
    v_mfma_f32_16x16x32_bf16 v[172:175], v[108:111], v[36:39], v[172:175]
    ds_read_b64_tr_b16 v[52:53], v8 offset:20480
    ds_read_b64_tr_b16 v[54:55], v8 offset:22528
    ds_read_b128 v[124:127], v19 offset:320
    s_waitcnt lgkmcnt(9)
    v_mfma_f32_16x16x32_bf16 v[172:175], v[112:115], v[40:43], v[172:175]
    s_waitcnt lgkmcnt(6)
    v_mfma_f32_16x16x32_bf16 v[172:175], v[116:119], v[44:47], v[172:175]
    s_waitcnt lgkmcnt(3)
    v_mfma_f32_16x16x32_bf16 v[172:175], v[120:123], v[48:51], v[172:175]
    s_waitcnt lgkmcnt(0)
    v_mfma_f32_16x16x32_bf16 v[172:175], v[124:127], v[52:55], v[172:175]
    s_mov_b64 exec, 0xffff
    s_nop 6
    v_mov_b32 v173, v4
    buffer_store_dwordx2 v[172:173], v18, s[52:55], s60 offen sc0 sc1
    s_mov_b64 exec, -1
G_H8:
    s_barrier
    s_mul_i32 s0, s7, 24576
    s_add_u32 m0, s62, s0
    s_cmp_lg_u32 s7, 0
    s_cbranch_scc1 G_Q3b
    buffer_load_dwordx4 v6, s[44:47], s64 offen nt lds
    s_add_u32 m0, m0, 8192
    s_add_u32 s64, s64, 524288
    buffer_load_dwordx4 v6, s[44:47], s64 offen nt lds
    s_add_u32 m0, m0, 8192
    s_add_u32 s64, s64, 524288
    buffer_load_dwordx4 v6, s[44:47], s64 offen nt lds
    s_add_u32 m0, m0, 8192
    s_add_u32 s64, s64, 524288
G_Q3b:
    buffer_load_dwordx4 v6, s[44:47], s64 offen nt lds
    s_add_u32 m0, m0, 8192
    s_add_u32 s64, s64, 524288
    buffer_load_dwordx4 v6, s[44:47], s64 offen nt lds
    s_add_u32 m0, m0, 8192
    s_add_u32 s64, s64, 524288
    buffer_load_dwordx4 v6, s[44:47], s64 offen nt lds
    s_mul_i32 s64, s4, 589824
    s_lshl_b32 s0, s5, 7
    s_add_u32 s64, s64, s0
    s_mul_i32 s0, s3, 9216
    s_add_u32 s64, s64, s0
G_H9:
    s_mov_b32 s58, 0
    s_cmp_lt_u32 s3, 4
    s_cbranch_scc1 G_B2
G_UP1:
    ds_read_b128 v[40:43], v26
    ds_read_b128 v[44:47], v26 offset:16
    ds_read_b64 v[48:49], v26 offset:32
    v_lshlrev_b32 v36, 16, v14
    v_and_b32 v37, 0xffff0000, v14
    s_waitcnt lgkmcnt(0)
    v_add_f32 v40, v40, v42
    v_add_f32 v41, v41, v43
    v_add_f32 v44, v44, v46
    v_add_f32 v45, v45, v47
    v_add_f32 v40, v40, v48
    v_add_f32 v41, v41, v49
    v_add_f32 v40, v40, v44
    v_add_f32 v41, v41, v45
    v_mul_f32 v42, 0x3ae38e39, v40
    v_mul_f32 v44, 0x3ae38e39, v41
    v_fma_f32 v44, -v42, v42, v44
    v_max_f32 v44, 0, v44
    v_cvt_pk_bf16_f32 v44, v42, v44
    v_lshlrev_b32 v42, 16, v44
    v_and_b32 v44, 0xffff0000, v44
    v_add_f32 v44, 0x3727c5ac, v44
    v_cvt_pk_bf16_f32 v44, v44, v44
    v_and_b32 v44, 0xffff0000, v44
    v_sqrt_f32 v44, v44
    s_nop 0
    v_cvt_pk_bf16_f32 v44, v44, v44
    v_and_b32 v44, 0xffff0000, v44
    v_rcp_f32 v43, v44
    v_sub_f32 v36, v36, v42
    v_sub_f32 v37, v37, v42
    v_cvt_pk_bf16_f32 v44, v36, v37
    v_lshlrev_b32 v36, 16, v44
    v_and_b32 v37, 0xffff0000, v44
    v_mul_f32 v36, v36, v43
    v_mul_f32 v37, v37, v43
    v_cvt_pk_bf16_f32 v44, v36, v37
    v_lshlrev_b32 v36, 16, v44
    v_and_b32 v37, 0xffff0000, v44
    s_mov_b32 s60, 4096
    s_mov_b32 s61, 13312
    s_mov_b32 s56, 22528
    s_mov_b32 s58, 0
    s_cmp_eq_u32 s3, 7
    s_cbranch_scc1 G_B2
    s_waitcnt vmcnt(1)
    buffer_load_dwordx4 v[40:43], v30, s[52:55], s60 offen sc1
    buffer_load_dwordx4 v[44:47], v31, s[52:55], s60 offen sc1
    buffer_load_dwordx4 v[48:51], v30, s[52:55], s61 offen sc1
    buffer_load_dwordx4 v[52:55], v31, s[52:55], s61 offen sc1
    buffer_load_dwordx4 v[56:59], v30, s[52:55], s56 offen sc1
    buffer_load_dwordx4 v[60:63], v31, s[52:55], s56 offen sc1
    s_waitcnt vmcnt(6)
    buffer_load_dwordx4 v[40:43], v30, s[52:55], s60 offen sc1
    buffer_load_dwordx4 v[44:47], v31, s[52:55], s60 offen sc1
    buffer_load_dwordx4 v[48:51], v30, s[52:55], s61 offen sc1
    buffer_load_dwordx4 v[52:55], v31, s[52:55], s61 offen sc1
    buffer_load_dwordx4 v[56:59], v30, s[52:55], s56 offen sc1
    buffer_load_dwordx4 v[60:63], v31, s[52:55], s56 offen sc1
    s_barrier
    s_branch G_UP2
G_B2:
    s_waitcnt vmcnt(0)
    s_barrier
    s_cmp_eq_u32 s3, 7
    s_cbranch_scc1 G_B3
    s_cmp_lg_u32 s7, 0
    s_cbranch_scc1 G_QB6
    ds_read_b64_tr_b16 v[32:33], v8 offset:0
    ds_read_b64_tr_b16 v[34:35], v8 offset:2048
    ds_read_b64_tr_b16 v[36:37], v8 offset:4096
    ds_read_b64_tr_b16 v[38:39], v8 offset:6144
    ds_read_b64_tr_b16 v[40:41], v8 offset:8192
    ds_read_b64_tr_b16 v[42:43], v8 offset:10240
    ds_read_b64_tr_b16 v[44:45], v8 offset:12288
    ds_read_b64_tr_b16 v[46:47], v8 offset:14336
    ds_read_b64_tr_b16 v[48:49], v8 offset:16384
    ds_read_b64_tr_b16 v[50:51], v8 offset:18432
    ds_read_b64_tr_b16 v[52:53], v8 offset:20480
    ds_read_b64_tr_b16 v[54:55], v8 offset:22528
    s_waitcnt lgkmcnt(0)
G_QB6:
    ds_read_b64_tr_b16 v[56:57], v8 offset:24576
    ds_read_b64_tr_b16 v[58:59], v8 offset:26624
    ds_read_b64_tr_b16 v[60:61], v8 offset:28672
    ds_read_b64_tr_b16 v[62:63], v8 offset:30720
    ds_read_b64_tr_b16 v[64:65], v8 offset:32768
    ds_read_b64_tr_b16 v[66:67], v8 offset:34816
    ds_read_b64_tr_b16 v[68:69], v8 offset:36864
    ds_read_b64_tr_b16 v[70:71], v8 offset:38912
    ds_read_b64_tr_b16 v[72:73], v8 offset:40960
    ds_read_b64_tr_b16 v[74:75], v8 offset:43008
    ds_read_b64_tr_b16 v[76:77], v8 offset:45056
    ds_read_b64_tr_b16 v[78:79], v8 offset:47104
    v_mov_b32 v172, 0
    v_mov_b32 v173, 0
    v_mov_b32 v174, 0
    v_mov_b32 v175, 0
    s_waitcnt lgkmcnt(0)
    s_barrier
    s_cmp_lg_u32 s7, 0
    s_cbranch_scc1 G_QA6
    ds_read_b128 v[104:107], v10 offset:1152
    ds_read_b128 v[108:111], v10 offset:1216
    ds_read_b128 v[112:115], v10 offset:1280
    ds_read_b128 v[116:119], v10 offset:1344
    ds_read_b128 v[120:123], v10 offset:1408
    ds_read_b128 v[124:127], v10 offset:1472
G_QA6:
    ds_read_b128 v[128:131], v10 offset:1536
    ds_read_b128 v[132:135], v10 offset:1600
    ds_read_b128 v[136:139], v10 offset:1664
    ds_read_b128 v[140:143], v10 offset:1728
    ds_read_b128 v[144:147], v10 offset:1792
    ds_read_b128 v[148:151], v10 offset:1856
    s_cbranch_scc1 G_QM6
    s_waitcnt lgkmcnt(11)
    v_mfma_f32_16x16x32_bf16 v[172:175], v[104:107], v[32:35], v[172:175]
    s_waitcnt lgkmcnt(10)
    v_mfma_f32_16x16x32_bf16 v[172:175], v[108:111], v[36:39], v[172:175]
    s_waitcnt lgkmcnt(9)
    v_mfma_f32_16x16x32_bf16 v[172:175], v[112:115], v[40:43], v[172:175]
    s_waitcnt lgkmcnt(8)
    v_mfma_f32_16x16x32_bf16 v[172:175], v[116:119], v[44:47], v[172:175]
    s_waitcnt lgkmcnt(7)
    v_mfma_f32_16x16x32_bf16 v[172:175], v[120:123], v[48:51], v[172:175]
    s_waitcnt lgkmcnt(6)
    v_mfma_f32_16x16x32_bf16 v[172:175], v[124:127], v[52:55], v[172:175]
G_QM6:
    s_waitcnt lgkmcnt(5)
    v_mfma_f32_16x16x32_bf16 v[172:175], v[128:131], v[56:59], v[172:175]
    s_waitcnt lgkmcnt(4)
    v_mfma_f32_16x16x32_bf16 v[172:175], v[132:135], v[60:63], v[172:175]
    s_waitcnt lgkmcnt(3)
    v_mfma_f32_16x16x32_bf16 v[172:175], v[136:139], v[64:67], v[172:175]
    s_waitcnt lgkmcnt(2)
    v_mfma_f32_16x16x32_bf16 v[172:175], v[140:143], v[68:71], v[172:175]
    s_waitcnt lgkmcnt(1)
    v_mfma_f32_16x16x32_bf16 v[172:175], v[144:147], v[72:75], v[172:175]
    s_waitcnt lgkmcnt(0)
    v_mfma_f32_16x16x32_bf16 v[172:175], v[148:151], v[76:79], v[172:175]
    s_mov_b64 exec, 0xffff
    s_nop 6
    v_mov_b32 v173, v4
    s_add_u32 s1, s65, 524288
    buffer_store_dwordx2 v[172:173], v18, s[52:55], s1 offen
    buffer_store_dwordx2 v[172:173], v18, s[52:55], s65 offen sc0 sc1
    s_mov_b64 exec, -1
    s_branch G_B3B
G_UP2:
G_H_C:
    s_waitcnt vmcnt(0)
    v_xor_b32 v64, v41, v4
    v_xor_b32 v65, v45, v4
    v_xor_b32 v66, v49, v4
    v_xor_b32 v67, v53, v4
    v_xor_b32 v68, v57, v4
    v_xor_b32 v69, v61, v4
    v_bitop3_b32 v64, v64, v43, v4 bitop3:0xf6
    v_bitop3_b32 v65, v65, v47, v4 bitop3:0xf6
    v_bitop3_b32 v66, v66, v51, v4 bitop3:0xf6
    v_bitop3_b32 v67, v67, v55, v4 bitop3:0xf6
    v_bitop3_b32 v68, v68, v59, v4 bitop3:0xf6
    v_bitop3_b32 v69, v69, v63, v4 bitop3:0xf6
    v_or3_b32 v70, v64, v65, v66
    v_or3_b32 v70, v70, v67, v68
    v_or_b32 v70, v70, v69
    v_cmp_ne_u32 vcc, 0, v70
    s_cbranch_vccnz G_H_F
    v_add_f32 v40, v40, v48
    v_add_f32 v42, v42, v50
    v_add_f32 v44, v44, v52
    v_add_f32 v46, v46, v54
    v_add_f32 v40, v40, v56
    v_add_f32 v42, v42, v58
    v_add_f32 v44, v44, v60
    v_add_f32 v46, v46, v62
    v_cvt_pk_bf16_f32 v64, v44, v46
    v_lshlrev_b32 v44, 16, v64
    v_and_b32 v46, 0xffff0000, v64
    v_cvt_pk_bf16_f32 v65, v40, v42
    v_lshlrev_b32 v40, 16, v65
    v_and_b32 v42, 0xffff0000, v65
    v_add_f32 v44, 1.0, v44
    v_add_f32 v46, 1.0, v46
    v_cvt_pk_bf16_f32 v64, v44, v46
    v_lshlrev_b32 v44, 16, v64
    v_and_b32 v46, 0xffff0000, v64
    v_mul_f32 v44, v36, v44
    v_mul_f32 v46, v37, v46
    v_cvt_pk_bf16_f32 v64, v44, v46
    v_lshlrev_b32 v44, 16, v64
    v_and_b32 v46, 0xffff0000, v64
    v_add_f32 v44, v44, v40
    v_add_f32 v46, v46, v42
    v_cvt_pk_bf16_f32 v44, v44, v46
    ds_write_b32 v24, v44
    s_waitcnt lgkmcnt(0)
G_B3:
    s_barrier
G_B3B:
    s_barrier
    s_lshl_b32 s68, s4, 3
    s_add_u32 s68, s68, s5
    s_add_u32 s68, s68, 120
    s_add_u32 m0, s62, 61440
    s_cmp_ge_u32 s5, 9
    s_cbranch_scc1 G_M
    s_cmp_lt_u32 s5, 8
    s_cbranch_scc1 G_NOMLP
    v_lshlrev_b32 v221, 4, v0
    v_lshlrev_b32 v222, 1, v0
    v_add_u32 v222, 0x2000, v222
    v_mov_b32 v223, 0
    global_load_dwordx4 v[206:209], v221, s[20:21]
    global_load_dwordx4 v[210:213], v221, s[22:23]
    global_load_dwordx4 v[214:217], v221, s[24:25]
    global_load_ushort v218, v222, s[20:21]
    global_load_ushort v219, v222, s[22:23]
    global_load_ushort v220, v222, s[24:25]
    global_load_ushort v223, v223, s[26:27]
    global_load_dword v12, v233, s[8:9]
G_NOMLP:
    s_add_u32 m0, m0, 0
    s_lshl_b32 s0, s4, 7
    s_add_u32 s0, s0, 475136
    buffer_load_dwordx2 v[36:37], v18, s[52:55], s0 offen sc1
    buffer_load_dwordx4 v7, s[48:51], s64 offen nt lds
    s_add_u32 m0, m0, 8192
    s_add_u32 s64, s64, 73728
    buffer_load_dwordx4 v7, s[48:51], s64 offen nt lds
    s_add_u32 m0, m0, 8192
    s_add_u32 s64, s64, 73728
    buffer_load_dwordx4 v7, s[48:51], s64 offen nt lds
    s_add_u32 m0, m0, 8192
    s_add_u32 s64, s64, 73728
    buffer_load_dwordx4 v7, s[48:51], s64 offen nt lds
    s_add_u32 m0, m0, 8192
    s_add_u32 s64, s64, 73728
    buffer_load_dwordx4 v7, s[48:51], s64 offen nt lds
    s_add_u32 m0, m0, 8192
    s_add_u32 s64, s64, 73728
    buffer_load_dwordx4 v7, s[48:51], s64 offen nt lds
    s_add_u32 m0, m0, 8192
    s_add_u32 s64, s64, 73728
    buffer_load_dwordx4 v7, s[48:51], s64 offen nt lds
    s_add_u32 m0, m0, 8192
    s_add_u32 s64, s64, 73728
    buffer_load_dwordx4 v7, s[48:51], s64 offen nt lds
    s_cmp_ge_u32 s3, 4
    s_cbranch_scc1 G_UP4
    s_mul_i32 s60, s4, 2304
    s_lshl_b32 s61, s5, 8
    s_add_u32 s60, s60, s61
    s_lshl_b32 s61, s3, 6
    s_add_u32 s60, s60, s61
    s_add_u32 s60, s60, 393216
    v_lshlrev_b32 v29, 2, v1
    s_waitcnt vmcnt(0)
    s_barrier
    ds_read_b64_tr_b16 v[32:33], v9 offset:0
    ds_read_b64_tr_b16 v[34:35], v9 offset:2048
    ds_read_b64_tr_b16 v[36:37], v9 offset:4096
    ds_read_b64_tr_b16 v[38:39], v9 offset:6144
    ds_read_b64_tr_b16 v[40:41], v9 offset:8192
    ds_read_b64_tr_b16 v[42:43], v9 offset:10240
    ds_read_b64_tr_b16 v[44:45], v9 offset:12288
    ds_read_b64_tr_b16 v[46:47], v9 offset:14336
    ds_read_b64_tr_b16 v[48:49], v9 offset:16384
    ds_read_b64_tr_b16 v[50:51], v9 offset:18432
    ds_read_b64_tr_b16 v[52:53], v9 offset:20480
    ds_read_b64_tr_b16 v[54:55], v9 offset:22528
    s_waitcnt lgkmcnt(0)
    ds_read_b64_tr_b16 v[56:57], v9 offset:24576
    ds_read_b64_tr_b16 v[58:59], v9 offset:26624
    ds_read_b64_tr_b16 v[60:61], v9 offset:28672
    ds_read_b64_tr_b16 v[62:63], v9 offset:30720
    ds_read_b64_tr_b16 v[64:65], v9 offset:32768
    ds_read_b64_tr_b16 v[66:67], v9 offset:34816
    ds_read_b64_tr_b16 v[68:69], v9 offset:36864
    ds_read_b64_tr_b16 v[70:71], v9 offset:38912
    ds_read_b64_tr_b16 v[72:73], v9 offset:40960
    ds_read_b64_tr_b16 v[74:75], v9 offset:43008
    ds_read_b64_tr_b16 v[76:77], v9 offset:45056
    ds_read_b64_tr_b16 v[78:79], v9 offset:47104
    s_waitcnt lgkmcnt(0)
    ds_read_b64_tr_b16 v[80:81], v9 offset:49152
    ds_read_b64_tr_b16 v[82:83], v9 offset:51200
    ds_read_b64_tr_b16 v[84:85], v9 offset:53248
    ds_read_b64_tr_b16 v[86:87], v9 offset:55296
    ds_read_b64_tr_b16 v[88:89], v9 offset:57344
    ds_read_b64_tr_b16 v[90:91], v9 offset:59392
    ds_read_b64_tr_b16 v[92:93], v9 offset:61440
    ds_read_b64_tr_b16 v[94:95], v9 offset:63488
    s_waitcnt lgkmcnt(0)
    s_barrier
    ds_read_b128 v[104:107], v10 offset:2304
    ds_read_b128 v[108:111], v10 offset:2368
    ds_read_b128 v[112:115], v10 offset:2432
    ds_read_b128 v[116:119], v10 offset:2496
    ds_read_b128 v[120:123], v10 offset:2560
    ds_read_b128 v[124:127], v10 offset:2624
    ds_read_b128 v[128:131], v10 offset:2688
    ds_read_b128 v[132:135], v10 offset:2752
    ds_read_b128 v[136:139], v10 offset:2816
    ds_read_b128 v[140:143], v10 offset:2880
    ds_read_b128 v[144:147], v10 offset:2944
    ds_read_b128 v[148:151], v10 offset:3008
    s_waitcnt lgkmcnt(11)
    v_mfma_f32_16x16x32_bf16 v[172:175], v[104:107], v[32:35], 0
    ds_read_b128 v[152:155], v10 offset:3072
    s_waitcnt lgkmcnt(11)
    v_mfma_f32_16x16x32_bf16 v[172:175], v[108:111], v[36:39], v[172:175]
    ds_read_b128 v[156:159], v10 offset:3136
    s_waitcnt lgkmcnt(11)
    v_mfma_f32_16x16x32_bf16 v[172:175], v[112:115], v[40:43], v[172:175]
    ds_read_b128 v[160:163], v10 offset:3200
    s_waitcnt lgkmcnt(11)
    v_mfma_f32_16x16x32_bf16 v[172:175], v[116:119], v[44:47], v[172:175]
    ds_read_b128 v[164:167], v10 offset:3264
    s_waitcnt lgkmcnt(11)
    v_mfma_f32_16x16x32_bf16 v[172:175], v[120:123], v[48:51], v[172:175]
    s_waitcnt lgkmcnt(10)
    v_mfma_f32_16x16x32_bf16 v[172:175], v[124:127], v[52:55], v[172:175]
    s_waitcnt lgkmcnt(9)
    v_mfma_f32_16x16x32_bf16 v[172:175], v[128:131], v[56:59], v[172:175]
    s_waitcnt lgkmcnt(8)
    v_mfma_f32_16x16x32_bf16 v[172:175], v[132:135], v[60:63], v[172:175]
    s_waitcnt lgkmcnt(7)
    v_mfma_f32_16x16x32_bf16 v[172:175], v[136:139], v[64:67], v[172:175]
    s_waitcnt lgkmcnt(6)
    v_mfma_f32_16x16x32_bf16 v[172:175], v[140:143], v[68:71], v[172:175]
    s_waitcnt lgkmcnt(5)
    v_mfma_f32_16x16x32_bf16 v[172:175], v[144:147], v[72:75], v[172:175]
    s_waitcnt lgkmcnt(4)
    v_mfma_f32_16x16x32_bf16 v[172:175], v[148:151], v[76:79], v[172:175]
    s_waitcnt lgkmcnt(3)
    v_mfma_f32_16x16x32_bf16 v[172:175], v[152:155], v[80:83], v[172:175]
    s_waitcnt lgkmcnt(2)
    v_mfma_f32_16x16x32_bf16 v[172:175], v[156:159], v[84:87], v[172:175]
    s_waitcnt lgkmcnt(1)
    v_mfma_f32_16x16x32_bf16 v[172:175], v[160:163], v[88:91], v[172:175]
    s_waitcnt lgkmcnt(0)
    v_mfma_f32_16x16x32_bf16 v[172:175], v[164:167], v[92:95], v[172:175]
    s_nop 7
    v_mov_b32_dpp v173, v172 quad_perm:[1,0,3,2] row_mask:0xf bank_mask:0xf
    s_mov_b64 exec, 0x5555
    v_cvt_pk_bf16_f32 v172, v172, v173
    v_mov_b32 v173, v4
    buffer_store_dwordx2 v[172:173], v29, s[52:55], s60 offen sc0 sc1
    s_mov_b64 exec, -1
    s_branch G_FIN
G_UP4:
    s_lshl_b32 s60, s4, 2
    s_add_u32 s60, s60, s3
    s_sub_u32 s60, s60, 4
    s_lshl_b32 s61, s60, 7
    s_add_u32 s61, s61, 360448
    s_lshl_b32 s60, s60, 12
    s_add_u32 s60, s60, 98304
    v_lshlrev_b32 v38, 4, v1
    v_lshrrev_b32 v41, 5, v1
    v_and_b32 v39, 3, v1
    v_lshl_add_u32 v39, v39, 1, v41
    v_lshlrev_b32 v39, 4, v39
    v_and_b32 v40, 31, v1
    v_lshl_add_u32 v40, v40, 1, v41
    s_sub_u32 s56, s3, 4
    s_lshl_b32 s56, s56, 6
    v_add_u32 v40, s56, v40
    v_lshrrev_b32 v24, 4, v40
    v_lshlrev_b32 v24, 6, v24
    v_bfe_u32 v20, v40, 1, 2
    v_lshl_add_u32 v24, v20, 4, v24
    v_bfe_u32 v20, v40, 3, 1
    v_lshl_add_u32 v24, v20, 3, v24
    v_and_b32 v20, 1, v40
    v_lshl_add_u32 v24, v20, 2, v24
    v_add_u32 v24, 137472, v24
    s_getreg_b32 s69, hwreg(HW_REG_XCC_ID)
    s_and_b32 s69, s69, 15
    s_waitcnt vmcnt(8)
G_ID:
    v_xor_b32 v74, v37, v4
    v_cmp_ne_u32 vcc, 0, v74
    s_nop 0
    s_and_b32 s1, vcc_lo, 0xffff
    s_cbranch_scc1 G_IDR
    v_cmp_ne_u32 vcc, s69, v36
    s_nop 0
    s_and_b32 s1, vcc_lo, 0xffff
    s_cselect_b32 s1, 0, 524288
    s_add_u32 s60, s60, s1
    s_add_u32 s61, s61, s1
    s_waitcnt vmcnt(1)
    buffer_load_dwordx4 v[32:35], v39, s[52:55], s61 offen sc1
    buffer_load_dwordx4 v[40:43], v38, s[52:55], s60 offen offset:0 sc1
    buffer_load_dwordx4 v[44:47], v38, s[52:55], s60 offen offset:1024 sc1
    buffer_load_dwordx4 v[48:51], v38, s[52:55], s60 offen offset:2048 sc1
    buffer_load_dwordx4 v[52:55], v38, s[52:55], s60 offen offset:3072 sc1
    s_waitcnt vmcnt(5)
    s_barrier
G_A_C:
    s_waitcnt vmcnt(0)
    v_xor_b32 v76, v33, v4
    v_xor_b32 v77, v41, v4
    v_xor_b32 v78, v45, v4
    v_xor_b32 v79, v49, v4
    v_xor_b32 v80, v53, v4
    v_bitop3_b32 v76, v76, v35, v4 bitop3:0xf6
    v_bitop3_b32 v77, v77, v43, v4 bitop3:0xf6
    v_bitop3_b32 v78, v78, v47, v4 bitop3:0xf6
    v_bitop3_b32 v79, v79, v51, v4 bitop3:0xf6
    v_bitop3_b32 v80, v80, v55, v4 bitop3:0xf6
    v_or3_b32 v81, v76, v77, v78
    v_or3_b32 v81, v81, v79, v80
    v_cmp_ne_u32 vcc, 0, v81
    s_cbranch_vccnz G_A_F
    v_max_f32_dpp v36, v32, v32 quad_perm:[1,0,3,2] row_mask:0xf bank_mask:0xf
    v_and_b32 v41, 0xffff0000, v40
    v_lshlrev_b32 v40, 16, v40
    v_max_f32_dpp v36, v36, v36 quad_perm:[2,3,0,1] row_mask:0xf bank_mask:0xf
    v_and_b32 v43, 0xffff0000, v42
    v_lshlrev_b32 v42, 16, v42
    v_mov_b32 v37, v36
    v_and_b32 v45, 0xffff0000, v44
    v_lshlrev_b32 v44, 16, v44
    v_permlane32_swap_b32 v36, v37
    v_and_b32 v47, 0xffff0000, v46
    v_lshlrev_b32 v46, 16, v46
    v_max_f32 v36, v36, v37
    v_sub_f32 v36, v32, v36
    v_exp_f32 v36, v36
    v_and_b32 v49, 0xffff0000, v48
    v_lshlrev_b32 v48, 16, v48
    v_mul_f32 v37, v36, v34
    v_mov_b32_dpp v56, v36 row_newbcast:0 row_mask:0xf bank_mask:0xf
    v_mov_b32_dpp v58, v36 row_newbcast:1 row_mask:0xf bank_mask:0xf
    v_add_f32_dpp v37, v37, v37 quad_perm:[1,0,3,2] row_mask:0xf bank_mask:0xf
    v_mov_b32_dpp v60, v36 row_newbcast:2 row_mask:0xf bank_mask:0xf
    v_mov_b32_dpp v62, v36 row_newbcast:3 row_mask:0xf bank_mask:0xf
    v_and_b32 v51, 0xffff0000, v50
    v_lshlrev_b32 v50, 16, v50
    v_add_f32_dpp v37, v37, v37 quad_perm:[2,3,0,1] row_mask:0xf bank_mask:0xf
    v_pk_mul_f32 v[72:73], v[40:41], v[56:57] op_sel_hi:[1,0]
    v_pk_mul_f32 v[74:75], v[42:43], v[56:57] op_sel_hi:[1,0]
    v_mov_b32 v38, v37
    v_and_b32 v53, 0xffff0000, v52
    v_lshlrev_b32 v52, 16, v52
    v_permlane32_swap_b32 v37, v38
    v_pk_fma_f32 v[72:73], v[44:45], v[58:59], v[72:73] op_sel_hi:[1,0,1]
    v_pk_fma_f32 v[74:75], v[46:47], v[58:59], v[74:75] op_sel_hi:[1,0,1]
    v_add_f32 v37, v37, v38
    v_and_b32 v55, 0xffff0000, v54
    v_lshlrev_b32 v54, 16, v54
    v_rcp_f32 v64, v37
    v_pk_fma_f32 v[72:73], v[48:49], v[60:61], v[72:73] op_sel_hi:[1,0,1]
    v_pk_fma_f32 v[74:75], v[50:51], v[60:61], v[74:75] op_sel_hi:[1,0,1]
    v_pk_fma_f32 v[72:73], v[52:53], v[62:63], v[72:73] op_sel_hi:[1,0,1]
    v_pk_fma_f32 v[74:75], v[54:55], v[62:63], v[74:75] op_sel_hi:[1,0,1]
    s_nop 1
    v_permlane32_swap_b32 v72, v74
    v_permlane32_swap_b32 v73, v75
    v_pk_add_f32 v[72:73], v[72:73], v[74:75]
    v_pk_mul_f32 v[72:73], v[72:73], v[64:65] op_sel_hi:[1,0]
    v_cvt_pk_bf16_f32 v72, v72, v73
    ds_write_b32 v24, v72
    s_waitcnt lgkmcnt(0)
    s_barrier
    s_branch G_FIN
G_M:
    s_cmp_ge_u32 s57, 36
    s_cbranch_scc1 G_NOM
    s_lshl_b32 s64, s57, 7
    s_add_u32 s64, s64, 2304
    s_mul_i32 s61, s3, 55296
    s_add_u32 s64, s64, s61
    buffer_load_dwordx4 v5, s[40:43], s64 offen nt lds
    s_add_u32 m0, m0, 8192
    s_add_u32 s64, s64, 442368
    buffer_load_dwordx4 v5, s[40:43], s64 offen nt lds
    s_add_u32 m0, m0, 8192
    s_add_u32 s64, s64, 442368
    buffer_load_dwordx4 v5, s[40:43], s64 offen nt lds
    s_add_u32 m0, m0, 8192
    s_add_u32 s64, s64, 442368
    buffer_load_dwordx4 v5, s[40:43], s64 offen nt lds
    s_add_u32 m0, m0, 8192
    s_add_u32 s64, s64, 442368
    buffer_load_dwordx4 v5, s[40:43], s64 offen nt lds
    s_add_u32 m0, m0, 8192
    s_add_u32 s64, s64, 442368
    buffer_load_dwordx4 v5, s[40:43], s64 offen nt lds
    s_add_u32 m0, m0, 8192
    s_add_u32 s64, s64, 442368
    buffer_load_dwordx4 v5, s[40:43], s64 offen nt lds
    s_add_u32 m0, m0, 8192
    s_add_u32 s64, s64, 442368
    buffer_load_dwordx4 v5, s[40:43], s64 offen nt lds
    s_add_u32 m0, m0, 8192
    s_add_u32 s64, s64, 442368
    buffer_load_dwordx4 v5, s[40:43], s64 offen nt lds
    v_lshlrev_b32 v221, 4, v0
    v_lshlrev_b32 v222, 1, v0
    v_add_u32 v222, 0x2000, v222
    v_mov_b32 v223, 0
    global_load_dwordx4 v[206:209], v221, s[20:21]
    global_load_dwordx4 v[210:213], v221, s[22:23]
    global_load_dwordx4 v[214:217], v221, s[24:25]
    global_load_ushort v218, v222, s[20:21]
    global_load_ushort v219, v222, s[22:23]
    global_load_ushort v220, v222, s[24:25]
    global_load_ushort v223, v223, s[26:27]
    global_load_dword v12, v233, s[8:9]
    s_lshr_b32 s61, s3, 2
    s_lshl_b32 s60, s57, 8
    s_lshl_b32 s56, s6, 6
    s_add_u32 s60, s60, s56
    s_add_u32 s60, s60, 434176
    s_add_u32 s56, s56, 137472
    v_lshl_add_u32 v24, v1, 2, s56
    v_lshlrev_b32 v29, 2, v1
    s_mul_i32 s56, s61, 36864
    v_add_u32 v9, s56, v9
    s_mul_i32 s56, s61, 576
    v_add_u32 v19, s56, v10
    s_waitcnt vmcnt(8)
    s_barrier
    ds_read_b64_tr_b16 v[32:33], v9 offset:0
    ds_read_b64_tr_b16 v[34:35], v9 offset:2048
    ds_read_b128 v[104:107], v19 offset:0
    ds_read_b64_tr_b16 v[36:37], v9 offset:4096
    ds_read_b64_tr_b16 v[38:39], v9 offset:6144
    ds_read_b128 v[108:111], v19 offset:64
    ds_read_b64_tr_b16 v[40:41], v9 offset:8192
    ds_read_b64_tr_b16 v[42:43], v9 offset:10240
    ds_read_b128 v[112:115], v19 offset:128
    ds_read_b64_tr_b16 v[44:45], v9 offset:12288
    ds_read_b64_tr_b16 v[46:47], v9 offset:14336
    ds_read_b128 v[116:119], v19 offset:192
    s_waitcnt lgkmcnt(9)
    v_mfma_f32_16x16x32_bf16 v[172:175], v[104:107], v[32:35], 0
    ds_read_b64_tr_b16 v[48:49], v9 offset:16384
    ds_read_b64_tr_b16 v[50:51], v9 offset:18432
    ds_read_b128 v[120:123], v19 offset:256
    s_waitcnt lgkmcnt(9)
    v_mfma_f32_16x16x32_bf16 v[172:175], v[108:111], v[36:39], v[172:175]
    ds_read_b64_tr_b16 v[52:53], v9 offset:20480
    ds_read_b64_tr_b16 v[54:55], v9 offset:22528
    ds_read_b128 v[124:127], v19 offset:320
    s_waitcnt lgkmcnt(9)
    v_mfma_f32_16x16x32_bf16 v[172:175], v[112:115], v[40:43], v[172:175]
    ds_read_b64_tr_b16 v[56:57], v9 offset:24576
    ds_read_b64_tr_b16 v[58:59], v9 offset:26624
    ds_read_b128 v[128:131], v19 offset:384
    s_waitcnt lgkmcnt(9)
    v_mfma_f32_16x16x32_bf16 v[172:175], v[116:119], v[44:47], v[172:175]
    ds_read_b64_tr_b16 v[60:61], v9 offset:28672
    ds_read_b64_tr_b16 v[62:63], v9 offset:30720
    ds_read_b128 v[132:135], v19 offset:448
    s_waitcnt lgkmcnt(9)
    v_mfma_f32_16x16x32_bf16 v[172:175], v[120:123], v[48:51], v[172:175]
    ds_read_b64_tr_b16 v[64:65], v9 offset:32768
    ds_read_b64_tr_b16 v[66:67], v9 offset:34816
    ds_read_b128 v[136:139], v19 offset:512
    s_waitcnt lgkmcnt(9)
    v_mfma_f32_16x16x32_bf16 v[172:175], v[124:127], v[52:55], v[172:175]
    s_waitcnt lgkmcnt(6)
    v_mfma_f32_16x16x32_bf16 v[172:175], v[128:131], v[56:59], v[172:175]
    s_waitcnt lgkmcnt(3)
    v_mfma_f32_16x16x32_bf16 v[172:175], v[132:135], v[60:63], v[172:175]
    s_waitcnt lgkmcnt(0)
    v_mfma_f32_16x16x32_bf16 v[172:175], v[136:139], v[64:67], v[172:175]
    s_cmp_lt_u32 s3, 4
    s_cbranch_scc1 G_M2
    s_mov_b64 exec, 0xffff
    s_nop 4
    ds_write_b32 v24, v172
    s_mov_b64 exec, -1
    s_waitcnt lgkmcnt(0)
    s_barrier
    s_branch L_F
G_M2:
    s_barrier
    ds_read_b32 v20, v24
    s_waitcnt lgkmcnt(0)
    v_add_f32 v172, v172, v20
    s_nop 1
    v_mov_b32_dpp v173, v172 quad_perm:[1,0,3,2] row_mask:0xf bank_mask:0xf
    s_mov_b64 exec, 0x5555
    v_cvt_pk_bf16_f32 v172, v172, v173
    v_mov_b32 v173, v4
    buffer_store_dwordx2 v[172:173], v29, s[52:55], s60 offen sc0 sc1
    s_mov_b64 exec, -1
    s_branch L_F
G_H_F:
    s_sub_u32 s39, s39, 1
    s_cbranch_scc1 L_FAIL
    v_cmp_eq_u32 vcc, 0, v64
    s_cbranch_vccz G_H_Z
    v_cmp_ne_u32 vcc, 0, v64
    s_cbranch_vccz G_H_K0
    buffer_load_dwordx4 v[40:43], v30, s[52:55], s60 offen sc1
G_H_K0:
    v_cmp_ne_u32 vcc, 0, v65
    s_cbranch_vccz G_H_K1
    buffer_load_dwordx4 v[44:47], v31, s[52:55], s60 offen sc1
G_H_K1:
    v_cmp_ne_u32 vcc, 0, v66
    s_cbranch_vccz G_H_K2
    buffer_load_dwordx4 v[48:51], v30, s[52:55], s61 offen sc1
G_H_K2:
    v_cmp_ne_u32 vcc, 0, v67
    s_cbranch_vccz G_H_K3
    buffer_load_dwordx4 v[52:55], v31, s[52:55], s61 offen sc1
G_H_K3:
    v_cmp_ne_u32 vcc, 0, v68
    s_cbranch_vccz G_H_K4
    buffer_load_dwordx4 v[56:59], v30, s[52:55], s56 offen sc1
G_H_K4:
    v_cmp_ne_u32 vcc, 0, v69
    s_cbranch_vccz G_H_K5
    buffer_load_dwordx4 v[60:63], v31, s[52:55], s56 offen sc1
G_H_K5:
    s_branch G_H_C
G_H_Z:
    s_mov_b64 exec, 0xff
G_H_Z1:
    buffer_load_dwordx4 v[40:43], v30, s[52:55], s60 offen sc1
    s_sub_u32 s39, s39, 1
    s_cbranch_scc1 L_FAIL
    s_waitcnt vmcnt(0)
    v_xor_b32 v64, v41, v4
    v_bitop3_b32 v64, v64, v43, v4 bitop3:0xf6
    v_cmp_eq_u32 vcc, 0, v64
    s_cbranch_vccz G_H_Z1
    s_mov_b64 exec, -1
    buffer_load_dwordx4 v[40:43], v30, s[52:55], s60 offen sc1
    buffer_load_dwordx4 v[44:47], v31, s[52:55], s60 offen sc1
    buffer_load_dwordx4 v[48:51], v30, s[52:55], s61 offen sc1
    buffer_load_dwordx4 v[52:55], v31, s[52:55], s61 offen sc1
    buffer_load_dwordx4 v[56:59], v30, s[52:55], s56 offen sc1
    buffer_load_dwordx4 v[60:63], v31, s[52:55], s56 offen sc1
    s_branch G_H_C
G_IDR:
    buffer_load_dwordx2 v[36:37], v18, s[52:55], s0 offen sc1
    s_sub_u32 s39, s39, 1
    s_cbranch_scc1 L_FAIL
    s_waitcnt vmcnt(0)
    s_branch G_ID
G_A_F:
    s_sub_u32 s39, s39, 1
    s_cbranch_scc1 L_FAIL
    v_cmp_eq_u32 vcc, 0, v76
    s_cbranch_vccz G_A_Z
    v_cmp_ne_u32 vcc, 0, v76
    s_cbranch_vccz G_A_K0
    buffer_load_dwordx4 v[32:35], v39, s[52:55], s61 offen sc1
G_A_K0:
    v_cmp_ne_u32 vcc, 0, v77
    s_cbranch_vccz G_A_K1
    buffer_load_dwordx4 v[40:43], v38, s[52:55], s60 offen offset:0 sc1
G_A_K1:
    v_cmp_ne_u32 vcc, 0, v78
    s_cbranch_vccz G_A_K2
    buffer_load_dwordx4 v[44:47], v38, s[52:55], s60 offen offset:1024 sc1
G_A_K2:
    v_cmp_ne_u32 vcc, 0, v79
    s_cbranch_vccz G_A_K3
    buffer_load_dwordx4 v[48:51], v38, s[52:55], s60 offen offset:2048 sc1
G_A_K3:
    v_cmp_ne_u32 vcc, 0, v80
    s_cbranch_vccz G_A_K4
    buffer_load_dwordx4 v[52:55], v38, s[52:55], s60 offen offset:3072 sc1
G_A_K4:
    s_branch G_A_C
G_A_Z:
    s_mov_b64 exec, 0xff
G_A_Z1:
    buffer_load_dwordx4 v[32:35], v39, s[52:55], s61 offen sc1
    s_sub_u32 s39, s39, 1
    s_cbranch_scc1 L_FAIL
    s_waitcnt vmcnt(0)
    v_xor_b32 v76, v33, v4
    v_bitop3_b32 v76, v76, v35, v4 bitop3:0xf6
    v_cmp_eq_u32 vcc, 0, v76
    s_cbranch_vccz G_A_Z1
    s_mov_b64 exec, -1
    buffer_load_dwordx4 v[32:35], v39, s[52:55], s61 offen sc1
    buffer_load_dwordx4 v[40:43], v38, s[52:55], s60 offen offset:0 sc1
    buffer_load_dwordx4 v[44:47], v38, s[52:55], s60 offen offset:1024 sc1
    buffer_load_dwordx4 v[48:51], v38, s[52:55], s60 offen offset:2048 sc1
    buffer_load_dwordx4 v[52:55], v38, s[52:55], s60 offen offset:3072 sc1
    s_branch G_A_C
G_NOM:
    v_lshlrev_b32 v221, 4, v0
    v_lshlrev_b32 v222, 1, v0
    v_add_u32 v222, 0x2000, v222
    v_mov_b32 v223, 0
    global_load_dwordx4 v[206:209], v221, s[20:21]
    global_load_dwordx4 v[210:213], v221, s[22:23]
    global_load_dwordx4 v[214:217], v221, s[24:25]
    global_load_ushort v218, v222, s[20:21]
    global_load_ushort v219, v222, s[22:23]
    global_load_ushort v220, v222, s[24:25]
    global_load_ushort v223, v223, s[26:27]
    global_load_dword v12, v233, s[8:9]
    s_branch L_F
G_FIN:
    s_cmp_lt_u32 s5, 8
    s_cbranch_scc1 L_EXIT
L_F:
    s_mul_i32 s68, s68, 3
    s_mov_b32 s66, -1
    s_cmp_eq_u32 s3, 4
    s_cselect_b32 s66, 0xffff, s66
    s_mov_b32 s67, s66
    v_lshlrev_b32 v19, 1, v233
    v_add_u32 v19, 135168, v19
    s_lshl_b32 s60, s3, 3
    s_add_u32 s60, s60, 144384
    v_mov_b32 v25, s60
    v_mov_b32 v26, 144384
    v_and_b32 v20, 3, v1
    v_add_u32 v27, s68, v20
    v_lshlrev_b32 v28, 1, v27
    v_lshlrev_b32 v27, 2, v27
    v_add_u32 v27, 135168, v27
    v_lshlrev_b32 v21, 2, v20
    v_add_u32 v21, 151424, v21
    s_lshl_b32 s60, s3, 4
    s_add_u32 s60, s60, 151424
    v_mov_b32 v22, s60
    v_mov_b32 v30, 0xc0135761
    s_mov_b32 s58, 0xbdd2d3e8
    s_waitcnt vmcnt(0)
    v_lshlrev_b32 v176, 16, v206
    v_and_b32 v177, 0xffff0000, v206
    v_lshlrev_b32 v178, 16, v207
    v_and_b32 v179, 0xffff0000, v207
    v_lshlrev_b32 v180, 16, v208
    v_and_b32 v181, 0xffff0000, v208
    v_lshlrev_b32 v182, 16, v209
    v_and_b32 v183, 0xffff0000, v209
    v_lshlrev_b32 v184, 16, v218
    v_lshlrev_b32 v186, 16, v210
    v_and_b32 v187, 0xffff0000, v210
    v_lshlrev_b32 v188, 16, v211
    v_and_b32 v189, 0xffff0000, v211
    v_lshlrev_b32 v190, 16, v212
    v_and_b32 v191, 0xffff0000, v212
    v_lshlrev_b32 v192, 16, v213
    v_and_b32 v193, 0xffff0000, v213
    v_lshlrev_b32 v194, 16, v219
    v_lshlrev_b32 v196, 16, v214
    v_and_b32 v197, 0xffff0000, v214
    v_lshlrev_b32 v198, 16, v215
    v_and_b32 v199, 0xffff0000, v215
    v_lshlrev_b32 v200, 16, v216
    v_and_b32 v201, 0xffff0000, v216
    v_lshlrev_b32 v202, 16, v217
    v_and_b32 v203, 0xffff0000, v217
    v_lshlrev_b32 v204, 16, v220
    v_lshlrev_b32 v223, 16, v223
    s_cmp_ge_u32 s3, 5
    s_cbranch_scc1 F_UP
    v_and_b32 v17, 0x1fe, v232
    v_lshlrev_b32 v17, 3, v17
    v_lshrrev_b32 v16, 5, v1
    v_mul_u32_u24 v15, 9216, v16
    v_add_u32 v15, v15, v17
    v_mul_u32_u24 v16, 4608, v16
    v_add_u32 v16, v16, v17
    v_and_b32 v14, 7, v1
    v_mul_u32_u24 v14, 2304, v14
    s_lshl_b32 s56, s3, 9
    s_add_u32 s56, s56, 393216
    s_mov_b32 s48, 434176
    s_mov_b32 s49, 436480
    v_lshlrev_b32 v50, 16, v12
    v_and_b32 v51, 0xffff0000, v12
    s_mov_b32 s40, 393216
    s_mov_b32 s41, 395520
    s_mov_b32 s42, 397824
    s_mov_b32 s43, 400128
    s_mov_b64 exec, 0xff
F_Y_S:
    buffer_load_dwordx2 v[64:65], v14, s[52:55], s56 offen sc1
    s_waitcnt vmcnt(0)
    v_xor_b32 v96, v65, v4
    v_cmp_eq_u32 vcc, 0, v96
    s_cbranch_vccz F_Y_SR
    s_mov_b64 exec, -1
    buffer_load_dwordx4 v[64:67], v15, s[52:55], s40 offen sc1
    buffer_load_dwordx4 v[68:71], v15, s[52:55], s41 offen sc1
    buffer_load_dwordx4 v[72:75], v15, s[52:55], s42 offen sc1
    buffer_load_dwordx4 v[76:79], v15, s[52:55], s43 offen sc1
    buffer_load_dwordx4 v[32:35], v16, s[52:55], s48 offen sc1
    buffer_load_dwordx4 v[36:39], v16, s[52:55], s49 offen sc1
F_Y_C:
    s_waitcnt vmcnt(0)
    v_xor_b32 v96, v65, v4
    v_xor_b32 v97, v69, v4
    v_xor_b32 v98, v73, v4
    v_xor_b32 v99, v77, v4
    v_xor_b32 v100, v33, v4
    v_xor_b32 v101, v37, v4
    v_bitop3_b32 v96, v96, v67, v4 bitop3:0xf6
    v_bitop3_b32 v97, v97, v71, v4 bitop3:0xf6
    v_bitop3_b32 v98, v98, v75, v4 bitop3:0xf6
    v_bitop3_b32 v99, v99, v79, v4 bitop3:0xf6
    v_bitop3_b32 v100, v100, v35, v4 bitop3:0xf6
    v_bitop3_b32 v101, v101, v39, v4 bitop3:0xf6
    v_or3_b32 v102, v96, v97, v98
    v_or3_b32 v102, v102, v99, v100
    v_or_b32 v102, v102, v101
    v_cmp_ne_u32 vcc, 0, v102
    s_cbranch_vccnz F_Y_F
    v_and_b32 v65, 0xffff0000, v64
    v_lshlrev_b32 v64, 16, v64
    v_and_b32 v67, 0xffff0000, v66
    v_lshlrev_b32 v66, 16, v66
    v_permlane32_swap_b32 v32, v34
    v_and_b32 v69, 0xffff0000, v68
    v_lshlrev_b32 v68, 16, v68
    v_and_b32 v71, 0xffff0000, v70
    v_lshlrev_b32 v70, 16, v70
    v_pk_add_f32 v[64:65], v[64:65], v[68:69]
    v_pk_add_f32 v[66:67], v[66:67], v[70:71]
    v_and_b32 v73, 0xffff0000, v72
    v_lshlrev_b32 v72, 16, v72
    v_and_b32 v75, 0xffff0000, v74
    v_lshlrev_b32 v74, 16, v74
    v_permlane32_swap_b32 v36, v38
    v_and_b32 v77, 0xffff0000, v76
    v_lshlrev_b32 v76, 16, v76
    v_and_b32 v79, 0xffff0000, v78
    v_lshlrev_b32 v78, 16, v78
    v_pk_add_f32 v[72:73], v[72:73], v[76:77]
    v_pk_add_f32 v[74:75], v[74:75], v[78:79]
    v_lshlrev_b32 v40, 16, v32
    v_pk_add_f32 v[64:65], v[64:65], v[72:73]
    v_pk_add_f32 v[66:67], v[66:67], v[74:75]
    v_and_b32 v41, 0xffff0000, v32
    v_lshlrev_b32 v46, 16, v38
    v_permlane32_swap_b32 v64, v66
    v_permlane32_swap_b32 v65, v67
    v_and_b32 v47, 0xffff0000, v38
    v_pk_add_f32 v[64:65], v[64:65], v[66:67]
    s_mov_b64 exec, s[66:67]
    ds_write_b64 v19, v[46:47] offset:13952
    s_mov_b64 exec, -1
    v_cvt_pk_bf16_f32 v48, v64, v65
    v_lshlrev_b32 v64, 16, v48
    v_and_b32 v65, 0xffff0000, v48
    v_pk_mul_f32 v[64:65], v[40:41], v[64:65]
    v_cvt_pk_bf16_f32 v48, v64, v65
    v_lshlrev_b32 v64, 16, v48
    v_and_b32 v65, 0xffff0000, v48
    v_pk_add_f32 v[50:51], v[50:51], v[64:65]
    v_cvt_pk_bf16_f32 v48, v50, v51
    v_lshlrev_b32 v50, 16, v48
    v_and_b32 v51, 0xffff0000, v48
    v_add_f32 v52, v50, v51
    v_mul_f32 v53, v50, v50
    v_fmac_f32 v53, v51, v51
    v_cndmask_b32 v52, 0, v52, s[66:67]
    v_cndmask_b32 v53, 0, v53, s[66:67]
    s_mov_b64 exec, s[66:67]
    ds_write_b64 v19, v[50:51] offset:11648
    s_mov_b64 exec, -1
    v_add_f32_dpp v52, v52, v52 row_shr:1 row_mask:0xf bank_mask:0xf
    v_add_f32_dpp v53, v53, v53 row_shr:1 row_mask:0xf bank_mask:0xf
    s_nop 0
    v_add_f32_dpp v52, v52, v52 row_shr:2 row_mask:0xf bank_mask:0xf
    v_add_f32_dpp v53, v53, v53 row_shr:2 row_mask:0xf bank_mask:0xf
    s_nop 0
    v_add_f32_dpp v52, v52, v52 row_shr:4 row_mask:0xf bank_mask:0xf
    v_add_f32_dpp v53, v53, v53 row_shr:4 row_mask:0xf bank_mask:0xf
    s_nop 0
    v_add_f32_dpp v52, v52, v52 row_shr:8 row_mask:0xf bank_mask:0xf
    v_add_f32_dpp v53, v53, v53 row_shr:8 row_mask:0xf bank_mask:0xf
    s_nop 0
    v_add_f32_dpp v52, v52, v52 row_bcast:15 row_mask:0xa bank_mask:0xf
    v_add_f32_dpp v53, v53, v53 row_bcast:15 row_mask:0xa bank_mask:0xf
    s_nop 0
    v_add_f32_dpp v52, v52, v52 row_bcast:31 row_mask:0xc bank_mask:0xf
    v_add_f32_dpp v53, v53, v53 row_bcast:31 row_mask:0xc bank_mask:0xf
    s_mov_b32 exec_lo, 0
    s_brev_b32 exec_hi, 1
    ds_write_b64 v25, v[52:53] offset:0
    s_mov_b64 exec, -1
    s_waitcnt lgkmcnt(0)
    s_barrier
    ds_read_b128 v[56:59], v26 offset:0
    ds_read_b128 v[60:63], v26 offset:16
    ds_read_b64 v[64:65], v26 offset:32
    v_lshlrev_b32 v44, 16, v34
    v_and_b32 v45, 0xffff0000, v34
    v_lshlrev_b32 v42, 16, v36
    v_and_b32 v43, 0xffff0000, v36
    v_pk_add_f32 v[44:45], v[44:45], 1.0 op_sel_hi:[1,0]
    v_cvt_pk_bf16_f32 v48, v44, v45
    v_lshlrev_b32 v44, 16, v48
    v_and_b32 v45, 0xffff0000, v48
    s_waitcnt lgkmcnt(0)
    v_pk_add_f32 v[56:57], v[56:57], v[58:59]
    v_pk_add_f32 v[60:61], v[60:61], v[62:63]
    v_pk_add_f32 v[56:57], v[56:57], v[64:65]
    v_pk_add_f32 v[56:57], v[56:57], v[60:61]
    v_mul_f32 v58, 0x3ae38e39, v56
    v_mul_f32 v60, 0x3ae38e39, v57
    v_fma_f32 v60, -v58, v58, v60
    v_max_f32 v60, 0, v60
    v_cvt_pk_bf16_f32 v60, v58, v60
    v_lshlrev_b32 v58, 16, v60
    v_and_b32 v60, 0xffff0000, v60
    v_add_f32 v60, 0x3727c5ac, v60
    v_cvt_pk_bf16_f32 v60, v60, v60
    v_and_b32 v60, 0xffff0000, v60
    v_sqrt_f32 v60, v60
    s_nop 0
    v_cvt_pk_bf16_f32 v60, v60, v60
    v_and_b32 v60, 0xffff0000, v60
    v_rcp_f32 v59, v60
    s_nop 0
    v_pk_add_f32 v[50:51], v[50:51], v[58:59] op_sel_hi:[1,0] neg_lo:[0,1] neg_hi:[0,1]
    v_cvt_pk_bf16_f32 v48, v50, v51
    v_lshlrev_b32 v50, 16, v48
    v_and_b32 v51, 0xffff0000, v48
    v_pk_mul_f32 v[50:51], v[50:51], v[58:59] op_sel:[0,1] op_sel_hi:[1,1]
    v_cvt_pk_bf16_f32 v48, v50, v51
    v_lshlrev_b32 v50, 16, v48
    v_and_b32 v51, 0xffff0000, v48
    v_pk_mul_f32 v[50:51], v[50:51], v[44:45]
    v_cvt_pk_bf16_f32 v48, v50, v51
    v_lshlrev_b32 v50, 16, v48
    v_and_b32 v51, 0xffff0000, v48
    v_pk_add_f32 v[50:51], v[50:51], v[42:43]
    v_cvt_pk_bf16_f32 v48, v50, v51
    v_lshlrev_b32 v50, 16, v48
    v_and_b32 v51, 0xffff0000, v48
    v_add_f32 v52, v50, v51
    v_mul_f32 v53, v50, v50
    v_fmac_f32 v53, v51, v51
    v_cndmask_b32 v52, 0, v52, s[66:67]
    v_cndmask_b32 v53, 0, v53, s[66:67]
    s_mov_b64 exec, s[66:67]
    ds_write_b64 v19, v[50:51] offset:9344
    s_mov_b64 exec, -1
    v_add_f32_dpp v52, v52, v52 row_shr:1 row_mask:0xf bank_mask:0xf
    v_add_f32_dpp v53, v53, v53 row_shr:1 row_mask:0xf bank_mask:0xf
    s_nop 0
    v_add_f32_dpp v52, v52, v52 row_shr:2 row_mask:0xf bank_mask:0xf
    v_add_f32_dpp v53, v53, v53 row_shr:2 row_mask:0xf bank_mask:0xf
    s_nop 0
    v_add_f32_dpp v52, v52, v52 row_shr:4 row_mask:0xf bank_mask:0xf
    v_add_f32_dpp v53, v53, v53 row_shr:4 row_mask:0xf bank_mask:0xf
    s_nop 0
    v_add_f32_dpp v52, v52, v52 row_shr:8 row_mask:0xf bank_mask:0xf
    v_add_f32_dpp v53, v53, v53 row_shr:8 row_mask:0xf bank_mask:0xf
    s_nop 0
    v_add_f32_dpp v52, v52, v52 row_bcast:15 row_mask:0xa bank_mask:0xf
    v_add_f32_dpp v53, v53, v53 row_bcast:15 row_mask:0xa bank_mask:0xf
    s_nop 0
    v_add_f32_dpp v52, v52, v52 row_bcast:31 row_mask:0xc bank_mask:0xf
    v_add_f32_dpp v53, v53, v53 row_bcast:31 row_mask:0xc bank_mask:0xf
    s_mov_b32 exec_lo, 0
    s_brev_b32 exec_hi, 1
    ds_write_b64 v25, v[52:53] offset:64
    s_mov_b64 exec, -1
    s_waitcnt lgkmcnt(0)
    s_branch F_B2
F_UP:
    s_barrier
    s_cmp_lg_u32 s2, 0
    s_cbranch_scc1 F_B2
    s_cmp_lg_u32 s3, 5
    s_cbranch_scc1 F_B2
    s_mov_b64 exec, 1
    buffer_store_dword v4, v18, s[52:55], 0 offen sc0 sc1
    s_mov_b64 exec, -1
F_B2:
    s_barrier
    ds_read_b128 v[56:59], v26 offset:64
    ds_read_b128 v[60:63], v26 offset:80
    ds_read_b64 v[64:65], v26 offset:96
    ds_read_b32 v50, v27 offset:9344
    s_waitcnt lgkmcnt(0)
    v_pk_add_f32 v[56:57], v[56:57], v[58:59]
    v_pk_add_f32 v[60:61], v[60:61], v[62:63]
    v_pk_add_f32 v[56:57], v[56:57], v[64:65]
    v_pk_add_f32 v[56:57], v[56:57], v[60:61]
    v_mul_f32 v58, 0x3ae38e39, v56
    v_mul_f32 v60, 0x3ae38e39, v57
    v_fma_f32 v60, -v58, v58, v60
    v_max_f32 v60, 0, v60
    v_cvt_pk_bf16_f32 v60, v58, v60
    v_lshlrev_b32 v58, 16, v60
    v_and_b32 v60, 0xffff0000, v60
    v_add_f32 v60, 0x3727c5ac, v60
    v_cvt_pk_bf16_f32 v60, v60, v60
    v_and_b32 v60, 0xffff0000, v60
    v_sqrt_f32 v60, v60
    s_nop 0
    v_cvt_pk_bf16_f32 v60, v60, v60
    v_and_b32 v60, 0xffff0000, v60
    v_rcp_f32 v59, v60
    v_sub_f32 v50, v50, v58
    v_cvt_pk_bf16_f32 v50, v50, v50
    v_and_b32 v50, 0xffff0000, v50
    v_mul_f32 v50, v50, v59
    v_cvt_pk_bf16_f32 v50, v50, v50
    v_and_b32 v50, 0xffff0000, v50
    s_nop 0
    v_readlane_b32 s60, v50, 0
    v_readlane_b32 s62, v50, 1
    v_readlane_b32 s64, v50, 2
    v_pk_fma_f32 v[32:33], v[176:177], s[60:61], v[186:187] op_sel_hi:[1,0,1]
    v_pk_fma_f32 v[34:35], v[178:179], s[60:61], v[188:189] op_sel_hi:[1,0,1]
    v_pk_fma_f32 v[36:37], v[180:181], s[60:61], v[190:191] op_sel_hi:[1,0,1]
    v_pk_fma_f32 v[38:39], v[182:183], s[60:61], v[192:193] op_sel_hi:[1,0,1]
    v_fma_f32 v40, s60, v184, v194
    v_pk_mul_f32 v[44:45], v[32:33], v[32:33]
    v_pk_mul_f32 v[46:47], v[34:35], v[34:35]
    v_pk_mul_f32 v[48:49], v[36:37], v[36:37]
    v_pk_mul_f32 v[50:51], v[38:39], v[38:39]
    v_mul_f32 v52, v40, v40
    v_pk_fma_f32 v[44:45], v[44:45], s[58:59], v[30:31] op_sel_hi:[1,0,0]
    v_pk_fma_f32 v[46:47], v[46:47], s[58:59], v[30:31] op_sel_hi:[1,0,0]
    v_pk_fma_f32 v[48:49], v[48:49], s[58:59], v[30:31] op_sel_hi:[1,0,0]
    v_pk_fma_f32 v[50:51], v[50:51], s[58:59], v[30:31] op_sel_hi:[1,0,0]
    v_fma_f32 v52, v52, s58, v30
    v_pk_mul_f32 v[44:45], v[44:45], v[32:33]
    v_pk_mul_f32 v[46:47], v[46:47], v[34:35]
    v_pk_mul_f32 v[48:49], v[48:49], v[36:37]
    v_pk_mul_f32 v[50:51], v[50:51], v[38:39]
    v_mul_f32 v52, v52, v40
    v_exp_f32 v44, v44
    v_exp_f32 v45, v45
    v_exp_f32 v46, v46
    v_exp_f32 v47, v47
    v_exp_f32 v48, v48
    v_exp_f32 v49, v49
    v_exp_f32 v50, v50
    v_exp_f32 v51, v51
    v_exp_f32 v52, v52
    v_pk_mul_f32 v[32:33], v[32:33], v[196:197]
    v_pk_mul_f32 v[34:35], v[34:35], v[198:199]
    v_pk_mul_f32 v[36:37], v[36:37], v[200:201]
    v_pk_mul_f32 v[38:39], v[38:39], v[202:203]
    v_mul_f32 v40, v40, v204
    v_pk_add_f32 v[44:45], v[44:45], 1.0 op_sel_hi:[1,0]
    v_pk_add_f32 v[46:47], v[46:47], 1.0 op_sel_hi:[1,0]
    v_pk_add_f32 v[48:49], v[48:49], 1.0 op_sel_hi:[1,0]
    v_pk_add_f32 v[50:51], v[50:51], 1.0 op_sel_hi:[1,0]
    v_add_f32 v52, 1.0, v52
    v_rcp_f32 v44, v44
    v_rcp_f32 v45, v45
    v_rcp_f32 v46, v46
    v_rcp_f32 v47, v47
    v_rcp_f32 v48, v48
    v_rcp_f32 v49, v49
    v_rcp_f32 v50, v50
    v_rcp_f32 v51, v51
    v_rcp_f32 v52, v52
    v_pk_mul_f32 v[56:57], v[32:33], v[44:45]
    v_pk_fma_f32 v[56:57], v[34:35], v[46:47], v[56:57]
    v_pk_fma_f32 v[56:57], v[36:37], v[48:49], v[56:57]
    v_pk_fma_f32 v[56:57], v[38:39], v[50:51], v[56:57]
    v_fmac_f32 v56, v40, v52
    v_pk_fma_f32 v[32:33], v[176:177], s[62:63], v[186:187] op_sel_hi:[1,0,1]
    v_pk_fma_f32 v[34:35], v[178:179], s[62:63], v[188:189] op_sel_hi:[1,0,1]
    v_pk_fma_f32 v[36:37], v[180:181], s[62:63], v[190:191] op_sel_hi:[1,0,1]
    v_pk_fma_f32 v[38:39], v[182:183], s[62:63], v[192:193] op_sel_hi:[1,0,1]
    v_fma_f32 v40, s62, v184, v194
    v_pk_mul_f32 v[44:45], v[32:33], v[32:33]
    v_pk_mul_f32 v[46:47], v[34:35], v[34:35]
    v_pk_mul_f32 v[48:49], v[36:37], v[36:37]
    v_pk_mul_f32 v[50:51], v[38:39], v[38:39]
    v_mul_f32 v52, v40, v40
    v_pk_fma_f32 v[44:45], v[44:45], s[58:59], v[30:31] op_sel_hi:[1,0,0]
    v_pk_fma_f32 v[46:47], v[46:47], s[58:59], v[30:31] op_sel_hi:[1,0,0]
    v_pk_fma_f32 v[48:49], v[48:49], s[58:59], v[30:31] op_sel_hi:[1,0,0]
    v_pk_fma_f32 v[50:51], v[50:51], s[58:59], v[30:31] op_sel_hi:[1,0,0]
    v_fma_f32 v52, v52, s58, v30
    v_pk_mul_f32 v[44:45], v[44:45], v[32:33]
    v_pk_mul_f32 v[46:47], v[46:47], v[34:35]
    v_pk_mul_f32 v[48:49], v[48:49], v[36:37]
    v_pk_mul_f32 v[50:51], v[50:51], v[38:39]
    v_mul_f32 v52, v52, v40
    v_exp_f32 v44, v44
    v_exp_f32 v45, v45
    v_exp_f32 v46, v46
    v_exp_f32 v47, v47
    v_exp_f32 v48, v48
    v_exp_f32 v49, v49
    v_exp_f32 v50, v50
    v_exp_f32 v51, v51
    v_exp_f32 v52, v52
    v_pk_mul_f32 v[32:33], v[32:33], v[196:197]
    v_pk_mul_f32 v[34:35], v[34:35], v[198:199]
    v_pk_mul_f32 v[36:37], v[36:37], v[200:201]
    v_pk_mul_f32 v[38:39], v[38:39], v[202:203]
    v_mul_f32 v40, v40, v204
    v_pk_add_f32 v[44:45], v[44:45], 1.0 op_sel_hi:[1,0]
    v_pk_add_f32 v[46:47], v[46:47], 1.0 op_sel_hi:[1,0]
    v_pk_add_f32 v[48:49], v[48:49], 1.0 op_sel_hi:[1,0]
    v_pk_add_f32 v[50:51], v[50:51], 1.0 op_sel_hi:[1,0]
    v_add_f32 v52, 1.0, v52
    v_rcp_f32 v44, v44
    v_rcp_f32 v45, v45
    v_rcp_f32 v46, v46
    v_rcp_f32 v47, v47
    v_rcp_f32 v48, v48
    v_rcp_f32 v49, v49
    v_rcp_f32 v50, v50
    v_rcp_f32 v51, v51
    v_rcp_f32 v52, v52
    v_pk_mul_f32 v[58:59], v[32:33], v[44:45]
    v_pk_fma_f32 v[58:59], v[34:35], v[46:47], v[58:59]
    v_pk_fma_f32 v[58:59], v[36:37], v[48:49], v[58:59]
    v_pk_fma_f32 v[58:59], v[38:39], v[50:51], v[58:59]
    v_fmac_f32 v58, v40, v52
    v_pk_fma_f32 v[32:33], v[176:177], s[64:65], v[186:187] op_sel_hi:[1,0,1]
    v_pk_fma_f32 v[34:35], v[178:179], s[64:65], v[188:189] op_sel_hi:[1,0,1]
    v_pk_fma_f32 v[36:37], v[180:181], s[64:65], v[190:191] op_sel_hi:[1,0,1]
    v_pk_fma_f32 v[38:39], v[182:183], s[64:65], v[192:193] op_sel_hi:[1,0,1]
    v_fma_f32 v40, s64, v184, v194
    v_pk_mul_f32 v[44:45], v[32:33], v[32:33]
    v_pk_mul_f32 v[46:47], v[34:35], v[34:35]
    v_pk_mul_f32 v[48:49], v[36:37], v[36:37]
    v_pk_mul_f32 v[50:51], v[38:39], v[38:39]
    v_mul_f32 v52, v40, v40
    v_pk_fma_f32 v[44:45], v[44:45], s[58:59], v[30:31] op_sel_hi:[1,0,0]
    v_pk_fma_f32 v[46:47], v[46:47], s[58:59], v[30:31] op_sel_hi:[1,0,0]
    v_pk_fma_f32 v[48:49], v[48:49], s[58:59], v[30:31] op_sel_hi:[1,0,0]
    v_pk_fma_f32 v[50:51], v[50:51], s[58:59], v[30:31] op_sel_hi:[1,0,0]
    v_fma_f32 v52, v52, s58, v30
    v_pk_mul_f32 v[44:45], v[44:45], v[32:33]
    v_pk_mul_f32 v[46:47], v[46:47], v[34:35]
    v_pk_mul_f32 v[48:49], v[48:49], v[36:37]
    v_pk_mul_f32 v[50:51], v[50:51], v[38:39]
    v_mul_f32 v52, v52, v40
    v_exp_f32 v44, v44
    v_exp_f32 v45, v45
    v_exp_f32 v46, v46
    v_exp_f32 v47, v47
    v_exp_f32 v48, v48
    v_exp_f32 v49, v49
    v_exp_f32 v50, v50
    v_exp_f32 v51, v51
    v_exp_f32 v52, v52
    v_pk_mul_f32 v[32:33], v[32:33], v[196:197]
    v_pk_mul_f32 v[34:35], v[34:35], v[198:199]
    v_pk_mul_f32 v[36:37], v[36:37], v[200:201]
    v_pk_mul_f32 v[38:39], v[38:39], v[202:203]
    v_mul_f32 v40, v40, v204
    v_pk_add_f32 v[44:45], v[44:45], 1.0 op_sel_hi:[1,0]
    v_pk_add_f32 v[46:47], v[46:47], 1.0 op_sel_hi:[1,0]
    v_pk_add_f32 v[48:49], v[48:49], 1.0 op_sel_hi:[1,0]
    v_pk_add_f32 v[50:51], v[50:51], 1.0 op_sel_hi:[1,0]
    v_add_f32 v52, 1.0, v52
    v_rcp_f32 v44, v44
    v_rcp_f32 v45, v45
    v_rcp_f32 v46, v46
    v_rcp_f32 v47, v47
    v_rcp_f32 v48, v48
    v_rcp_f32 v49, v49
    v_rcp_f32 v50, v50
    v_rcp_f32 v51, v51
    v_rcp_f32 v52, v52
    v_pk_mul_f32 v[60:61], v[32:33], v[44:45]
    v_pk_fma_f32 v[60:61], v[34:35], v[46:47], v[60:61]
    v_pk_fma_f32 v[60:61], v[36:37], v[48:49], v[60:61]
    v_pk_fma_f32 v[60:61], v[38:39], v[50:51], v[60:61]
    v_fmac_f32 v60, v40, v52
    v_add_f32 v64, v56, v57
    v_add_f32 v65, v58, v59
    v_add_f32 v66, v60, v61
    v_add_f32_dpp v64, v64, v64 row_shr:1 row_mask:0xf bank_mask:0xf
    v_add_f32_dpp v65, v65, v65 row_shr:1 row_mask:0xf bank_mask:0xf
    v_add_f32_dpp v66, v66, v66 row_shr:1 row_mask:0xf bank_mask:0xf
    v_add_f32_dpp v64, v64, v64 row_shr:2 row_mask:0xf bank_mask:0xf
    v_add_f32_dpp v65, v65, v65 row_shr:2 row_mask:0xf bank_mask:0xf
    v_add_f32_dpp v66, v66, v66 row_shr:2 row_mask:0xf bank_mask:0xf
    v_add_f32_dpp v64, v64, v64 row_shr:4 row_mask:0xf bank_mask:0xf
    v_add_f32_dpp v65, v65, v65 row_shr:4 row_mask:0xf bank_mask:0xf
    v_add_f32_dpp v66, v66, v66 row_shr:4 row_mask:0xf bank_mask:0xf
    v_add_f32_dpp v64, v64, v64 row_shr:8 row_mask:0xf bank_mask:0xf
    v_add_f32_dpp v65, v65, v65 row_shr:8 row_mask:0xf bank_mask:0xf
    v_add_f32_dpp v66, v66, v66 row_shr:8 row_mask:0xf bank_mask:0xf
    v_add_f32_dpp v64, v64, v64 row_bcast:15 row_mask:0xa bank_mask:0xf
    v_add_f32_dpp v65, v65, v65 row_bcast:15 row_mask:0xa bank_mask:0xf
    v_add_f32_dpp v66, v66, v66 row_bcast:15 row_mask:0xa bank_mask:0xf
    v_add_f32_dpp v64, v64, v64 row_bcast:31 row_mask:0xc bank_mask:0xf
    v_add_f32_dpp v65, v65, v65 row_bcast:31 row_mask:0xc bank_mask:0xf
    v_add_f32_dpp v66, v66, v66 row_bcast:31 row_mask:0xc bank_mask:0xf
    s_mov_b32 exec_lo, 0
    s_brev_b32 exec_hi, 1
    ds_write_b96 v22, v[64:66]
    s_mov_b64 exec, -1
    s_waitcnt lgkmcnt(0)
    s_barrier
    s_cmp_lg_u32 s3, 0
    s_cbranch_scc1 L_EXIT
    ds_read2_b32 v[32:33], v21 offset0:0 offset1:4
    ds_read2_b32 v[34:35], v21 offset0:8 offset1:12
    ds_read2_b32 v[36:37], v21 offset0:16 offset1:20
    ds_read2_b32 v[38:39], v21 offset0:24 offset1:28
    ds_read_b32 v42, v27 offset:13952
    ds_read_b32 v43, v27 offset:11648
    s_mov_b32 s60, 7
    s_waitcnt lgkmcnt(2)
    v_pk_add_f32 v[32:33], v[32:33], v[34:35]
    v_pk_add_f32 v[36:37], v[36:37], v[38:39]
    v_pk_add_f32 v[32:33], v[32:33], v[36:37]
    v_add_f32 v32, v32, v33
F_FIN1:
    v_cvt_pk_bf16_f32 v32, v32, v32
    v_and_b32 v32, 0xffff0000, v32
    v_add_f32 v32, v32, v223
    v_cvt_pk_bf16_f32 v32, v32, v32
    v_and_b32 v32, 0xffff0000, v32
    s_waitcnt lgkmcnt(0)
    v_mul_f32 v32, v42, v32
    v_cvt_pk_bf16_f32 v32, v32, v32
    v_and_b32 v32, 0xffff0000, v32
    v_add_f32 v32, v43, v32
    v_cvt_pk_bf16_f32 v32, v32, v32
    s_mov_b32 exec_lo, s60
    s_mov_b32 exec_hi, 0
    global_store_short v28, v32, s[32:33]
    s_mov_b64 exec, -1
L_EXIT:
L_END:
    s_endpgm
F_Y_SR:
    s_sub_u32 s39, s39, 1
    s_cbranch_scc1 L_FAIL
    s_branch F_Y_S
F_Y_F:
    s_sub_u32 s39, s39, 1
    s_cbranch_scc1 L_FAIL
    v_cmp_ne_u32 vcc, 0, v96
    s_cbranch_vccz F_Y_K0
    buffer_load_dwordx4 v[64:67], v15, s[52:55], s40 offen sc1
F_Y_K0:
    v_cmp_ne_u32 vcc, 0, v97
    s_cbranch_vccz F_Y_K1
    buffer_load_dwordx4 v[68:71], v15, s[52:55], s41 offen sc1
F_Y_K1:
    v_cmp_ne_u32 vcc, 0, v98
    s_cbranch_vccz F_Y_K2
    buffer_load_dwordx4 v[72:75], v15, s[52:55], s42 offen sc1
F_Y_K2:
    v_cmp_ne_u32 vcc, 0, v99
    s_cbranch_vccz F_Y_K3
    buffer_load_dwordx4 v[76:79], v15, s[52:55], s43 offen sc1
F_Y_K3:
    v_cmp_ne_u32 vcc, 0, v100
    s_cbranch_vccz F_Y_K4
    buffer_load_dwordx4 v[32:35], v16, s[52:55], s48 offen sc1
F_Y_K4:
    v_cmp_ne_u32 vcc, 0, v101
    s_cbranch_vccz F_Y_K5
    buffer_load_dwordx4 v[36:39], v16, s[52:55], s49 offen sc1
F_Y_K5:
    s_branch F_Y_C
L_FAIL:
    s_mov_b64 exec, -1
    v_mov_b32 v20, 0
    v_mov_b32 v21, 0xdead
    global_store_dword v20, v21, s[34:35]
    s_branch L_EXIT
L_CEND:
.section .rodata,"a"
.p2align 6
.amdhsa_kernel adaLN_cond__sliding_block_cached__mixer_token_mlp__decode_kernel
  .amdhsa_next_free_vgpr 240
  .amdhsa_next_free_sgpr 102
  .amdhsa_accum_offset 240
  .amdhsa_group_segment_fixed_size 0
  .amdhsa_kernarg_size 120
  .amdhsa_user_sgpr_count 2
  .amdhsa_user_sgpr_kernarg_segment_ptr 1
  .amdhsa_system_sgpr_workgroup_id_x 1
.end_amdhsa_kernel
```
